```python
import torch

def _softmax(x, axis=-1):
    return torch.softmax(x, dim=axis)
def _gelu(x):
    return torch.nn.functional.gelu(x, approximate="tanh")
def _silu(x):
    return torch.nn.functional.silu(x)
def _sigmoid(x):
    return torch.sigmoid(x)
def _layernorm(x, axis=-1, eps=1e-5):
    m = x.mean(dim=axis, keepdim=True)
    v = x.var(dim=axis, keepdim=True, unbiased=False)
    return (x - m) / torch.sqrt(v + eps)
def _scatter_add(tgt, idx, src, axis=0):
    return tgt.clone().index_add_(axis, idx, src)
def _segment_sum(src, seg, n):
    out = torch.zeros((n,) + src.shape[1:], dtype=src.dtype)
    return out.index_add_(0, seg, src)
def _pad(x, pw):
    flat = tuple(v for pair in reversed(pw) for v in pair)
    return torch.nn.functional.pad(x, flat)

kernel_name = 'sequential_preLN__spectral_fnet__swiglu_ffn__prompt'

def setup_inputs():

    _w = (lambda a: (lambda t: t.to(torch.bfloat16) if t.is_floating_point() else t)(torch.as_tensor(a)))
    def _A_setup():
        B, S, D = 1, 2048, 512
        ns = torch.arange(S)[:, None] * torch.arange(S)[None, :]
        nd = torch.arange(D)[:, None] * torch.arange(D)[None, :]
        Ws_re = torch.cos(-2.0 * torch.pi * ns / S).to(float)
        Ws_im = torch.sin(-2.0 * torch.pi * ns / S).to(float)
        Wd_re = torch.cos(-2.0 * torch.pi * nd / D).to(float)
        Wd_im = torch.sin(-2.0 * torch.pi * nd / D).to(float)
        return {
            "x": _w((lambda *s: torch.randn(*s, dtype=torch.bfloat16) * 0.05)(B, S, D)),
            "dft_seq_re": _w(Ws_re),
            "dft_seq_im": _w(Ws_im),
            "dft_hid_re": _w(Wd_re),
            "dft_hid_im": _w(Wd_im),
        }
    _A_in = _A_setup()

    def _B_setup():
        B, S, D, F = 1, 2048, 512, 1376
        return {
            "x": _w((lambda *s: torch.randn(*s, dtype=torch.bfloat16) * 0.05)(B, S, D)),
            "w_gate": _w((lambda *s: torch.randn(*s, dtype=torch.bfloat16) * 0.2)(D, F)),
            "w_up": _w((lambda *s: torch.randn(*s, dtype=torch.bfloat16) * 0.2)(D, F)),
            "w_down": _w((lambda *s: torch.randn(*s, dtype=torch.bfloat16) * 0.2)(F, D)),
        }
    _B_in = _B_setup()

    return {
        "A_x": _A_in["x"],
        "A_dft_seq_re": _A_in["dft_seq_re"],
        "A_dft_seq_im": _A_in["dft_seq_im"],
        "A_dft_hid_re": _A_in["dft_hid_re"],
        "A_dft_hid_im": _A_in["dft_hid_im"],
        "B_x": _B_in["x"],
        "B_w_gate": _B_in["w_gate"],
        "B_w_up": _B_in["w_up"],
        "B_w_down": _B_in["w_down"],
    }

def reference(A_x, A_dft_seq_re, A_dft_seq_im, A_dft_hid_re, A_dft_hid_im, B_x, B_w_gate, B_w_up, B_w_down):
    def _A_ref(x, dft_seq_re, dft_seq_im, dft_hid_re, dft_hid_im):
        a = torch.einsum("bsd,ed->bse", x, dft_hid_re)
        b = torch.einsum("bsd,ed->bse", x, dft_hid_im)
        y = torch.einsum("ts,bse->bte", dft_seq_re, a) - torch.einsum("ts,bse->bte", dft_seq_im, b)
        return y

    def _B_ref(x, w_gate, w_up, w_down):
        g = _silu(x @ w_gate)
        u = x @ w_up
        return (g * u) @ w_down

    x = A_x
    h = x + _A_ref(_layernorm(x, axis=-1), A_dft_seq_re, A_dft_seq_im, A_dft_hid_re, A_dft_hid_im)
    h2 = h + _B_ref(_layernorm(h, axis=-1), B_w_gate, B_w_up, B_w_down)
    return h2
```

```asm
; @launch grid=(256,1,1) block=(512,1,1) lds=163840
.amdgcn_target "amdgcn-amd-amdhsa--gfx950"
.text
.globl sequential_preLN__spectral_fnet__swiglu_ffn__prompt_kernel
.p2align 8
.type sequential_preLN__spectral_fnet__swiglu_ffn__prompt_kernel,@function
sequential_preLN__spectral_fnet__swiglu_ffn__prompt_kernel:
  s_load_dwordx2 s[4:5], s[0:1], 0
  s_load_dwordx4 s[16:19], s[0:1], 48
  s_load_dwordx8 s[20:27], s[0:1], 64
  s_cmp_ge_u32 s2, 256
  s_cbranch_scc1 Lend
  s_getpc_b64 s[6:7]
Lpc:
  v_lshrrev_b32 v5, 6, v0
  s_lshr_b32 s92, s2, 3
  v_readfirstlane_b32 s93, v5
  s_lshl_b32 s72, s92, 10
  v_lshl_add_u32 v5, v5, 7, s72
  v_min_u32 v5, Lend-Lpc, v5
  global_load_dword v63, v5, s[6:7]
  v_and_b32 v1, 63, v0
  v_lshlrev_b32 v4, 4, v1
  s_and_b32 s77, s2, 7
  s_bfe_u32 s73, s2, 0x10005
  s_lshl_b32 s73, s73, 3
  s_add_u32 s72, s77, s73
  s_bfe_u32 s73, s2, 0x10006
  s_sub_u32 s74, 32, s72
  s_cmp_eq_u32 s72, 0
  s_cselect_b32 s74, 16, s74
  s_cmp_eq_u32 s73, 0
  s_cselect_b32 s65, s72, s74
  s_lshr_b32 s73, s2, 7
  s_lshl_b32 s73, s73, 5
  s_add_u32 s65, s65, s73
  s_and_b32 s64, s93, 3
  s_lshl_b32 s72, s64, 6
  v_xor_b32 v6, s72, v4
  s_lshl_b32 s74, s64, 18
  s_lshl_b32 s75, s65, 10
  s_add_u32 s74, s74, s75
  s_lshl_b32 s75, s64, 12
  s_add_u32 m0, s75, 123136
  s_and_b32 s66, s92, 3
  v_and_b32 v2, 15, v0
  v_lshrrev_b32 v3, 4, v1
  v_mov_b32 v0, 163584
  v_mov_b32 v8, 0
  v_and_b32 v7, 31, v1
  v_lshl_add_u32 v7, v7, 2, v0
  ds_write_b32 v7, v8
  s_mov_b32 s30, 2097152
  s_mov_b32 s31, 0x20000
  s_lshl_b32 s76, s2, 3
  s_add_u32 s76, s76, s93
  s_and_b32 s76, s76, 2023
  s_mov_b32 s50, 0x1000000
  s_mov_b32 s51, 0x20000
  s_waitcnt lgkmcnt(0)
  s_barrier
  s_mov_b32 s48, s26
  s_and_b32 s49, s27, 0xffff
  s_cmp_lg_u32 s76, 4
  s_cbranch_scc1 L1
  v_mov_b32 v12, 0
  v_mov_b32 v13, 0
  v_mov_b32 v14, 0
  v_mov_b32 v15, 0
  s_lshl_b32 s78, s2, 12
  buffer_store_dwordx4 v[12:15], v4, s[48:51], s78 offen offset:0 sc1
  buffer_store_dwordx4 v[12:15], v4, s[48:51], s78 offen offset:1024 sc1
  buffer_store_dwordx4 v[12:15], v4, s[48:51], s78 offen offset:2048 sc1
  buffer_store_dwordx4 v[12:15], v4, s[48:51], s78 offen offset:3072 sc1
L1:
  s_cmp_ge_u32 s93, 4
  s_cbranch_scc1 Lhelper
  s_mov_b32 s28, s4
  s_and_b32 s29, s5, 0xffff
  buffer_load_dwordx4 v6, s[28:31], s74 offen offset:0 lds
  v_xor_b32 v5, 16, v6
  s_add_u32 s74, s74, 64512
  buffer_load_dwordx4 v5, s[28:31], s74 offen offset:1024 lds
  v_xor_b32 v5, 32, v6
  s_add_u32 s74, s74, 64512
  buffer_load_dwordx4 v5, s[28:31], s74 offen offset:2048 lds
  v_xor_b32 v5, 48, v6
  s_add_u32 s74, s74, 64512
  buffer_load_dwordx4 v5, s[28:31], s74 offen offset:3072 lds
  s_add_u32 s74, s74, 855040
  s_add_u32 m0, m0, 16384
  s_nop 0
  buffer_load_dwordx4 v6, s[28:31], s74 offen offset:0 lds
  v_xor_b32 v5, 16, v6
  s_add_u32 s74, s74, 64512
  buffer_load_dwordx4 v5, s[28:31], s74 offen offset:1024 lds
  v_xor_b32 v5, 32, v6
  s_add_u32 s74, s74, 64512
  buffer_load_dwordx4 v5, s[28:31], s74 offen offset:2048 lds
  v_xor_b32 v5, 48, v6
  s_add_u32 s74, s74, 64512
  buffer_load_dwordx4 v5, s[28:31], s74 offen offset:3072 lds
  v_mov_b32 v5, 1
  s_mov_b64 exec, 1
  ds_add_u32 v0, v5 offset:48
  s_mov_b64 exec, -1
  s_setprio 1
  s_mov_b64 s[60:61], s[26:27]
  s_lshl_b32 s73, s66, 6
  s_add_u32 s73, s73, s64
  v_lshl_add_u32 v7, v2, 2, s73
  v_mov_b32 v8, 256
  v_cmp_eq_u32 vcc, 0, v7
  v_cvt_f32_u32 v9, v3
  s_nop 0
  v_cndmask_b32 v7, v7, v8, vcc
  v_cvt_f32_u32 v7, v7
  v_mul_f32 v7, 0xbb000000, v7
  v_mul_f32 v8, 0x41000000, v9
  v_mul_f32 v8, v7, v8
  v_mov_b32 v40, v8
  v_fma_f32 v41, v7, 1.0, v8
  v_cos_f32 v42, v40
  v_cos_f32 v43, v41
  v_sin_f32 v44, v40
  v_sin_f32 v45, v41
  v_cvt_pk_bf16_f32 v64, v42, v43
  v_cvt_pk_bf16_f32 v80, v44, v45
  v_fma_f32 v40, v7, 2.0, v8
  v_fmamk_f32 v41, v7, 0x40400000, v8
  v_cos_f32 v42, v40
  v_cos_f32 v43, v41
  v_sin_f32 v44, v40
  v_sin_f32 v45, v41
  v_cvt_pk_bf16_f32 v65, v42, v43
  v_cvt_pk_bf16_f32 v81, v44, v45
  v_fma_f32 v40, v7, 4.0, v8
  v_fmamk_f32 v41, v7, 0x40a00000, v8
  v_cos_f32 v42, v40
  v_cos_f32 v43, v41
  v_sin_f32 v44, v40
  v_sin_f32 v45, v41
  v_cvt_pk_bf16_f32 v66, v42, v43
  v_cvt_pk_bf16_f32 v82, v44, v45
  v_fmamk_f32 v40, v7, 0x40c00000, v8
  v_fmamk_f32 v41, v7, 0x40e00000, v8
  v_cos_f32 v42, v40
  v_cos_f32 v43, v41
  v_sin_f32 v44, v40
  v_sin_f32 v45, v41
  v_cvt_pk_bf16_f32 v67, v42, v43
  v_cvt_pk_bf16_f32 v83, v44, v45
  v_fmamk_f32 v40, v7, 0x42000000, v8
  v_fmamk_f32 v41, v7, 0x42040000, v8
  v_cos_f32 v42, v40
  v_cos_f32 v43, v41
  v_sin_f32 v44, v40
  v_sin_f32 v45, v41
  v_cvt_pk_bf16_f32 v68, v42, v43
  v_cvt_pk_bf16_f32 v84, v44, v45
  v_fmamk_f32 v40, v7, 0x42080000, v8
  v_fmamk_f32 v41, v7, 0x420c0000, v8
  v_cos_f32 v42, v40
  v_cos_f32 v43, v41
  v_sin_f32 v44, v40
  v_sin_f32 v45, v41
  v_cvt_pk_bf16_f32 v69, v42, v43
  v_cvt_pk_bf16_f32 v85, v44, v45
  v_fmamk_f32 v40, v7, 0x42100000, v8
  v_fmamk_f32 v41, v7, 0x42140000, v8
  v_cos_f32 v42, v40
  v_cos_f32 v43, v41
  v_sin_f32 v44, v40
  v_sin_f32 v45, v41
  v_cvt_pk_bf16_f32 v70, v42, v43
  v_cvt_pk_bf16_f32 v86, v44, v45
  v_fmamk_f32 v40, v7, 0x42180000, v8
  v_fmamk_f32 v41, v7, 0x421c0000, v8
  v_cos_f32 v42, v40
  v_cos_f32 v43, v41
  v_sin_f32 v44, v40
  v_sin_f32 v45, v41
  v_cvt_pk_bf16_f32 v71, v42, v43
  v_cvt_pk_bf16_f32 v87, v44, v45
  v_fmamk_f32 v40, v7, 0x42800000, v8
  v_fmamk_f32 v41, v7, 0x42820000, v8
  v_cos_f32 v42, v40
  v_cos_f32 v43, v41
  v_sin_f32 v44, v40
  v_sin_f32 v45, v41
  v_cvt_pk_bf16_f32 v72, v42, v43
  v_cvt_pk_bf16_f32 v88, v44, v45
  v_fmamk_f32 v40, v7, 0x42840000, v8
  v_fmamk_f32 v41, v7, 0x42860000, v8
  v_cos_f32 v42, v40
  v_cos_f32 v43, v41
  v_sin_f32 v44, v40
  v_sin_f32 v45, v41
  v_cvt_pk_bf16_f32 v73, v42, v43
  v_cvt_pk_bf16_f32 v89, v44, v45
  v_fmamk_f32 v40, v7, 0x42880000, v8
  v_fmamk_f32 v41, v7, 0x428a0000, v8
  v_cos_f32 v42, v40
  v_cos_f32 v43, v41
  v_sin_f32 v44, v40
  v_sin_f32 v45, v41
  v_cvt_pk_bf16_f32 v74, v42, v43
  v_cvt_pk_bf16_f32 v90, v44, v45
  v_fmamk_f32 v40, v7, 0x428c0000, v8
  v_fmamk_f32 v41, v7, 0x428e0000, v8
  v_cos_f32 v42, v40
  v_cos_f32 v43, v41
  v_sin_f32 v44, v40
  v_sin_f32 v45, v41
  v_cvt_pk_bf16_f32 v75, v42, v43
  v_cvt_pk_bf16_f32 v91, v44, v45
  v_fmamk_f32 v40, v7, 0x42c00000, v8
  v_fmamk_f32 v41, v7, 0x42c20000, v8
  v_cos_f32 v42, v40
  v_cos_f32 v43, v41
  v_sin_f32 v44, v40
  v_sin_f32 v45, v41
  v_cvt_pk_bf16_f32 v76, v42, v43
  v_cvt_pk_bf16_f32 v92, v44, v45
  v_fmamk_f32 v40, v7, 0x42c40000, v8
  v_fmamk_f32 v41, v7, 0x42c60000, v8
  v_cos_f32 v42, v40
  v_cos_f32 v43, v41
  v_sin_f32 v44, v40
  v_sin_f32 v45, v41
  v_cvt_pk_bf16_f32 v77, v42, v43
  v_cvt_pk_bf16_f32 v93, v44, v45
  v_fmamk_f32 v40, v7, 0x42c80000, v8
  v_fmamk_f32 v41, v7, 0x42ca0000, v8
  v_cos_f32 v42, v40
  v_cos_f32 v43, v41
  v_sin_f32 v44, v40
  v_sin_f32 v45, v41
  v_cvt_pk_bf16_f32 v78, v42, v43
  v_cvt_pk_bf16_f32 v94, v44, v45
  v_fmamk_f32 v40, v7, 0x42cc0000, v8
  v_fmamk_f32 v41, v7, 0x42ce0000, v8
  v_cos_f32 v42, v40
  v_cos_f32 v43, v41
  v_sin_f32 v44, v40
  v_sin_f32 v45, v41
  v_cvt_pk_bf16_f32 v79, v42, v43
  v_cvt_pk_bf16_f32 v95, v44, v45
  s_mul_i32 s72, s77, 28
  s_add_u32 s72, s72, s92
  s_lshr_b32 s90, s72, 4
  s_and_b32 s91, s72, 15
  s_lshl_b32 s72, s77, 1
  s_bfe_u32 s73, s92, 0x10001
  s_add_u32 s72, s72, s73
  s_and_b32 s73, s92, 1
  s_add_u32 s73, s73, 14
  s_cmp_ge_u32 s92, 28
  s_cselect_b32 s90, s73, s90
  s_cselect_b32 s91, s72, s91
  s_and_b32 s67, s2, 15
  s_lshr_b32 s68, s2, 4
  s_and_b32 s71, s68, 1
  s_lshr_b32 s70, s68, 1
  s_sub_u32 s72, 32, s67
  s_cmp_eq_u32 s67, 0
  s_cselect_b32 s72, 16, s72
  s_cmp_eq_u32 s71, 0
  s_cselect_b32 s69, s67, s72
  s_mov_b32 s3, 0x3f803f80
  s_cmp_eq_u32 s90, 15
  s_cselect_b32 s68, 0x400, s91
  s_lshl_b32 s72, s64, 4
  v_add_u32 v56, s72, v2
  s_cmp_lg_u32 s69, 0
  s_cbranch_scc1 L2
  s_lshl_b32 s72, s64, 3
  v_and_b32 v5, 7, v2
  v_add_u32 v5, s72, v5
  v_sub_u32 v6, 64, v5
  v_cmp_eq_u32 vcc, 0, v5
  s_nop 1
  v_cndmask_b32 v6, v6, 32, vcc
  v_cmp_gt_u32 vcc, 8, v2
  s_nop 1
  v_cndmask_b32 v56, v6, v5, vcc
L2:
  v_lshl_add_u32 v60, v56, 5, s69
  s_lshr_b32 s72, s70, 1
  s_lshl_b32 s72, s72, 7
  s_and_b32 s73, s70, 1
  s_lshl_b32 s73, s73, 2
  s_add_u32 s72, s72, s73
  v_lshl_add_u32 v62, v3, 5, s72
  v_lshl_add_u32 v58, v60, 10, v62
  v_sub_u32 v60, 0x800, v60
  v_and_b32 v60, 0x7ff, v60
  v_lshlrev_b32 v60, 10, v60
  v_sub_u32 v59, v60, v62
  v_add_u32 v59, 996, v59
  v_cmp_eq_u32 vcc, 0, v62
  v_mov_b32 v61, 1.0
  s_nop 0
  v_cndmask_b32 v61, v61, 0, vcc
  s_mov_b32 s44, s22
  s_and_b32 s45, s23, 0xffff
  s_mov_b32 s46, 2097152
  s_mov_b32 s47, 0x20000
  v_xor_b32 v5, v3, v2
  v_lshlrev_b32 v5, 4, v5
  v_lshl_add_u32 v8, v2, 10, v5
  v_xor_b32 v9, 64, v8
  v_xor_b32 v10, 128, v8
  v_xor_b32 v11, 192, v8
  v_add_u32 v8, 123136, v8
  v_add_u32 v9, 123136, v9
  v_add_u32 v10, 123136, v10
  v_add_u32 v11, 123136, v11
  v_lshlrev_b32 v12, 4, v3
  v_add_u32 v12, 156160, v12
  v_add_u32 v14, 158720, v4
  v_lshlrev_b32 v7, 16, v2
  v_lshl_add_u32 v7, v3, 4, v7
  s_lshr_b32 s72, s64, 1
  s_lshl_b32 s73, s66, 1
  s_add_u32 s72, s72, s73
  s_lshl_b32 s72, s72, 13
  s_lshl_b32 s73, s65, 7
  s_add_u32 s72, s72, s73
  s_lshr_b32 s73, s65, 1
  s_xor_b32 s73, s73, s64
  s_and_b32 s73, s73, 1
  s_lshl_b32 s73, s73, 6
  s_add_u32 s72, s72, s73
  s_add_u32 s80, s72, 1048576
  s_bitcmp1_b32 s65, 3
  s_cselect_b32 s94, 0x80008000, 0
  s_cselect_b32 s95, 0, 0x80008000
  s_lshl_b32 s72, s64, 12
  s_add_u32 s72, s72, 123136
  v_lshl_add_u32 v15, v3, 10, s72
  v_lshl_add_u32 v15, v2, 4, v15
  s_lshl_b32 s72, s64, 4
  s_add_u32 s72, s72, 156160
  v_lshl_add_u32 v13, v3, 2, s72
  v_mov_b32 v16, 0
  v_mov_b32 v17, 0
  v_mov_b32 v18, 0
  v_mov_b32 v19, 0
  v_mov_b32 v20, 0
  v_mov_b32 v21, 0
  v_mov_b32 v22, 0
  v_mov_b32 v23, 0
  s_waitcnt vmcnt(0)
  ds_read_b128 v[24:27], v15 offset:0
  ds_read_b128 v[28:31], v15 offset:256
  ds_read_b128 v[32:35], v15 offset:512
  ds_read_b128 v[36:39], v15 offset:768
  ds_read_b128 v[40:43], v15 offset:16384
  ds_read_b128 v[44:47], v15 offset:16640
  ds_read_b128 v[48:51], v15 offset:16896
  ds_read_b128 v[52:55], v15 offset:17152
  s_waitcnt lgkmcnt(7)
  v_dot2c_f32_bf16 v16, s3, v24
  v_dot2c_f32_bf16 v17, v24, v24
  v_dot2c_f32_bf16 v18, s3, v25
  v_dot2c_f32_bf16 v19, v25, v25
  v_dot2c_f32_bf16 v16, s3, v26
  v_dot2c_f32_bf16 v17, v26, v26
  v_dot2c_f32_bf16 v18, s3, v27
  v_dot2c_f32_bf16 v19, v27, v27
  s_waitcnt lgkmcnt(6)
  v_dot2c_f32_bf16 v16, s3, v28
  v_dot2c_f32_bf16 v17, v28, v28
  v_dot2c_f32_bf16 v18, s3, v29
  v_dot2c_f32_bf16 v19, v29, v29
  v_dot2c_f32_bf16 v16, s3, v30
  v_dot2c_f32_bf16 v17, v30, v30
  v_dot2c_f32_bf16 v18, s3, v31
  v_dot2c_f32_bf16 v19, v31, v31
  s_waitcnt lgkmcnt(5)
  v_dot2c_f32_bf16 v16, s3, v32
  v_dot2c_f32_bf16 v17, v32, v32
  v_dot2c_f32_bf16 v18, s3, v33
  v_dot2c_f32_bf16 v19, v33, v33
  v_dot2c_f32_bf16 v16, s3, v34
  v_dot2c_f32_bf16 v17, v34, v34
  v_dot2c_f32_bf16 v18, s3, v35
  v_dot2c_f32_bf16 v19, v35, v35
  s_waitcnt lgkmcnt(4)
  v_dot2c_f32_bf16 v16, s3, v36
  v_dot2c_f32_bf16 v17, v36, v36
  v_dot2c_f32_bf16 v18, s3, v37
  v_dot2c_f32_bf16 v19, v37, v37
  v_dot2c_f32_bf16 v16, s3, v38
  v_dot2c_f32_bf16 v17, v38, v38
  v_dot2c_f32_bf16 v18, s3, v39
  v_dot2c_f32_bf16 v19, v39, v39
  s_waitcnt lgkmcnt(3)
  v_dot2c_f32_bf16 v20, s3, v40
  v_dot2c_f32_bf16 v21, v40, v40
  v_dot2c_f32_bf16 v22, s3, v41
  v_dot2c_f32_bf16 v23, v41, v41
  v_dot2c_f32_bf16 v20, s3, v42
  v_dot2c_f32_bf16 v21, v42, v42
  v_dot2c_f32_bf16 v22, s3, v43
  v_dot2c_f32_bf16 v23, v43, v43
  s_waitcnt lgkmcnt(2)
  v_dot2c_f32_bf16 v20, s3, v44
  v_dot2c_f32_bf16 v21, v44, v44
  v_dot2c_f32_bf16 v22, s3, v45
  v_dot2c_f32_bf16 v23, v45, v45
  v_dot2c_f32_bf16 v20, s3, v46
  v_dot2c_f32_bf16 v21, v46, v46
  v_dot2c_f32_bf16 v22, s3, v47
  v_dot2c_f32_bf16 v23, v47, v47
  s_waitcnt lgkmcnt(1)
  v_dot2c_f32_bf16 v20, s3, v48
  v_dot2c_f32_bf16 v21, v48, v48
  v_dot2c_f32_bf16 v22, s3, v49
  v_dot2c_f32_bf16 v23, v49, v49
  v_dot2c_f32_bf16 v20, s3, v50
  v_dot2c_f32_bf16 v21, v50, v50
  v_dot2c_f32_bf16 v22, s3, v51
  v_dot2c_f32_bf16 v23, v51, v51
  s_waitcnt lgkmcnt(0)
  v_dot2c_f32_bf16 v20, s3, v52
  v_dot2c_f32_bf16 v21, v52, v52
  v_dot2c_f32_bf16 v22, s3, v53
  v_dot2c_f32_bf16 v23, v53, v53
  v_dot2c_f32_bf16 v20, s3, v54
  v_dot2c_f32_bf16 v21, v54, v54
  v_dot2c_f32_bf16 v22, s3, v55
  v_dot2c_f32_bf16 v23, v55, v55
  v_mov_b32 v24, 0x3727c5ac
  v_add_f32 v16, v16, v18
  v_add_f32 v17, v17, v19
  v_add_f32 v20, v20, v22
  v_add_f32 v21, v21, v23
  v_add_f32 v16, v16, v16 quad_perm:[1,0,3,2] row_mask:0xf bank_mask:0xf
  v_add_f32 v17, v17, v17 quad_perm:[1,0,3,2] row_mask:0xf bank_mask:0xf
  v_add_f32 v20, v20, v20 quad_perm:[1,0,3,2] row_mask:0xf bank_mask:0xf
  v_add_f32 v21, v21, v21 quad_perm:[1,0,3,2] row_mask:0xf bank_mask:0xf
  v_add_f32 v16, v16, v16 quad_perm:[2,3,0,1] row_mask:0xf bank_mask:0xf
  v_add_f32 v17, v17, v17 quad_perm:[2,3,0,1] row_mask:0xf bank_mask:0xf
  v_add_f32 v20, v20, v20 quad_perm:[2,3,0,1] row_mask:0xf bank_mask:0xf
  v_add_f32 v21, v21, v21 quad_perm:[2,3,0,1] row_mask:0xf bank_mask:0xf
  v_add_f32 v16, v16, v16 row_half_mirror row_mask:0xf bank_mask:0xf
  v_add_f32 v17, v17, v17 row_half_mirror row_mask:0xf bank_mask:0xf
  v_add_f32 v20, v20, v20 row_half_mirror row_mask:0xf bank_mask:0xf
  v_add_f32 v21, v21, v21 row_half_mirror row_mask:0xf bank_mask:0xf
  v_add_f32 v16, v16, v16 row_mirror row_mask:0xf bank_mask:0xf
  v_add_f32 v17, v17, v17 row_mirror row_mask:0xf bank_mask:0xf
  v_add_f32 v20, v20, v20 row_mirror row_mask:0xf bank_mask:0xf
  v_add_f32 v21, v21, v21 row_mirror row_mask:0xf bank_mask:0xf
  v_mul_f32 v16, 0x3b000000, v16
  v_fmamk_f32 v17, v17, 0x3b000000, v24
  v_mul_f32 v20, 0x3b000000, v20
  v_fmamk_f32 v21, v21, 0x3b000000, v24
  v_fma_f32 v17, -v16, v16, v17
  v_fma_f32 v21, -v20, v20, v21
  v_max_f32 v17, v17, v24
  v_max_f32 v21, v21, v24
  v_rsq_f32 v17, v17
  v_rsq_f32 v21, v21
  s_nop 0
  ds_write2_b32 v13, v17, v21 offset0:0 offset1:16
  v_mov_b32 v5, 1
  s_mov_b64 exec, 1
  ds_add_u32 v0, v5 offset:52
  s_mov_b64 exec, -1
  s_branch Lc1
Lhelper:
  s_mul_i32 s72, s77, 28
  s_add_u32 s72, s72, s92
  s_lshr_b32 s90, s72, 4
  s_and_b32 s91, s72, 15
  s_lshl_b32 s72, s77, 1
  s_bfe_u32 s73, s92, 0x10001
  s_add_u32 s72, s72, s73
  s_and_b32 s73, s92, 1
  s_add_u32 s73, s73, 14
  s_cmp_ge_u32 s92, 28
  s_cselect_b32 s90, s73, s90
  s_cselect_b32 s91, s72, s91
  s_and_b32 s67, s2, 15
  s_lshr_b32 s68, s2, 4
  s_and_b32 s71, s68, 1
  s_lshr_b32 s70, s68, 1
  s_sub_u32 s72, 32, s67
  s_cmp_eq_u32 s67, 0
  s_cselect_b32 s72, 16, s72
  s_cmp_eq_u32 s71, 0
  s_cselect_b32 s69, s67, s72
  s_mov_b32 s3, 0x3f803f80
  s_cmp_eq_u32 s90, 15
  s_cselect_b32 s68, 0x400, s91
  s_mov_b64 s[60:61], s[26:27]
  s_cmp_lg_u32 s93, 4
  s_cbranch_scc0 Lh4
  s_mov_b32 s32, s16
  s_and_b32 s33, s17, 0xffff
  s_mov_b32 s34, 1409024
  s_mov_b32 s35, 0x20000
  s_mov_b32 s36, s18
  s_and_b32 s37, s19, 0xffff
  s_mov_b32 s38, 1409024
  s_mov_b32 s39, 0x20000
  s_mul_i32 s80, s90, 192
  s_add_u32 s81, s80, 1243904
  s_sub_u32 s72, s64, 1
  s_lshl_b32 s83, s72, 10
  s_lshl_b32 s73, s72, 6
  v_add_u32 v5, s73, v1
  v_mul_u32_u24 v8, 0x1556, v5
  v_lshrrev_b32 v8, 16, v8
  v_mul_u32_u24 v10, 12, v8
  v_cmp_gt_u32 vcc, 12, v5
  v_sub_u32 v5, v5, v10
  v_lshlrev_b32 v5, 4, v5
  v_mul_u32_u24 v8, 11008, v8
  v_add_u32 v50, v8, v5
  v_sub_u32 v51, v5, v8
  v_add_u32 v51, 165120, v51
  v_add_u32 v52, 704512, v51
  v_cndmask_b32 v52, v52, v51, vcc
  v_add_u32 v5, s80, v5
  v_cmp_lt_u32 vcc, 2751, v5
  v_mov_b32 v8, 0
  v_mov_b32 v10, 0x40000000
  v_cndmask_b32 v8, v8, v10, vcc
  v_add_u32 v50, v50, v8
  v_add_u32 v51, v51, v8
  v_add_u32 v52, v52, v8
  s_mov_b32 s79, 0x400000
L72:
  ds_read_b32 v5, v0 offset:48
  s_waitcnt lgkmcnt(0)
  v_cmp_gt_u32 vcc, 4, v5
  s_cbranch_vccz L73
  s_sleep 1
  s_sub_u32 s79, s79, 1
  s_cbranch_scc0 L72
L73:
  s_setprio 0
  s_add_u32 m0, s83, 0
  s_add_u32 s96, s80, 0
  buffer_load_dwordx4 v50, s[32:35], s96 offen lds
  s_add_u32 m0, s83, 12320
  s_nop 0
  buffer_load_dwordx4 v50, s[36:39], s96 offen lds
  s_add_u32 m0, s83, 3072
  s_add_u32 s96, s80, 2752
  buffer_load_dwordx4 v50, s[32:35], s96 offen lds
  s_add_u32 m0, s83, 15392
  s_nop 0
  buffer_load_dwordx4 v50, s[36:39], s96 offen lds
  s_add_u32 m0, s83, 6144
  s_add_u32 s96, s80, 5504
  buffer_load_dwordx4 v50, s[32:35], s96 offen lds
  s_add_u32 m0, s83, 18464
  s_waitcnt vmcnt(9)
  buffer_load_dwordx4 v50, s[36:39], s96 offen lds
  s_add_u32 m0, s83, 9216
  s_add_u32 s96, s80, 8256
  s_waitcnt vmcnt(9)
  buffer_load_dwordx4 v50, s[32:35], s96 offen lds
  s_add_u32 m0, s83, 21536
  s_waitcnt vmcnt(9)
  buffer_load_dwordx4 v50, s[36:39], s96 offen lds
  s_add_u32 m0, s83, 24608
  s_add_u32 s96, s80, 176128
  s_waitcnt vmcnt(9)
  buffer_load_dwordx4 v50, s[32:35], s96 offen lds
  s_add_u32 m0, s83, 36928
  s_waitcnt vmcnt(9)
  buffer_load_dwordx4 v50, s[36:39], s96 offen lds
  s_add_u32 m0, s83, 27680
  s_add_u32 s96, s80, 178880
  s_waitcnt vmcnt(9)
  buffer_load_dwordx4 v50, s[32:35], s96 offen lds
  s_add_u32 m0, s83, 40000
  s_waitcnt vmcnt(9)
  buffer_load_dwordx4 v50, s[36:39], s96 offen lds
  s_add_u32 m0, s83, 30752
  s_add_u32 s96, s80, 181632
  s_waitcnt vmcnt(9)
  buffer_load_dwordx4 v50, s[32:35], s96 offen lds
  s_add_u32 m0, s83, 43072
  s_waitcnt vmcnt(9)
  buffer_load_dwordx4 v50, s[36:39], s96 offen lds
  s_add_u32 m0, s83, 33824
  s_add_u32 s96, s80, 184384
  s_waitcnt vmcnt(9)
  buffer_load_dwordx4 v50, s[32:35], s96 offen lds
  s_add_u32 m0, s83, 46144
  s_waitcnt vmcnt(9)
  buffer_load_dwordx4 v50, s[36:39], s96 offen lds
  s_branch Ls1
Lh4:
  s_mov_b32 s40, s20
  s_and_b32 s41, s21, 0xffff
  s_mov_b32 s42, 1409024
  s_mov_b32 s43, 0x20000
  s_and_b32 s72, s2, 1
  s_lshl_b32 s73, s66, 1
  s_add_u32 s94, s72, s73
  s_bfe_u32 s72, s2, 0x20001
  s_and_b32 s73, s92, 28
  s_add_u32 s95, s72, s73
  s_lshl_b32 s72, s94, 7
  s_lshl_b32 s73, s95, 15
  s_add_u32 s75, s72, s73
  s_add_u32 s76, s75, 1048576
  v_lshlrev_b32 v10, 13, v3
  v_lshl_add_u32 v10, v2, 3, v10
  v_add_u32 v11, 4096, v10
  s_mov_b32 s32, s16
  s_and_b32 s33, s17, 0xffff
  s_mov_b32 s34, 1409024
  s_mov_b32 s35, 0x20000
  s_mov_b32 s36, s18
  s_and_b32 s37, s19, 0xffff
  s_mov_b32 s38, 1409024
  s_mov_b32 s39, 0x20000
  s_mul_i32 s96, s2, 5504
  v_min_u32 v61, 42, v1
  v_lshlrev_b32 v61, 7, v61
  s_mov_b32 s79, 0x400000
L82:
  ds_read_b32 v5, v0 offset:48
  s_waitcnt lgkmcnt(0)
  v_cmp_gt_u32 vcc, 4, v5
  s_cbranch_vccz L83
  s_sleep 1
  s_sub_u32 s79, s79, 1
  s_cbranch_scc0 L82
L83:
  s_setprio 2
  buffer_load_dword v63, v61, s[32:35], s96 offen
  buffer_load_dword v63, v61, s[36:39], s96 offen
  s_cmp_ge_u32 s2, 4
  s_cbranch_scc1 L84
  s_waitcnt vmcnt(2)
  s_mov_b32 s62, 1
  s_atomic_add s62, s[24:25], 0x0
L84:
  buffer_load_dwordx2 v[80:81], v10, s[40:43], s75 offen offset:0
  buffer_load_dwordx2 v[82:83], v10, s[40:43], s75 offen offset:1024
  buffer_load_dwordx2 v[84:85], v10, s[40:43], s75 offen offset:2048
  buffer_load_dwordx2 v[86:87], v10, s[40:43], s75 offen offset:3072
  buffer_load_dwordx2 v[88:89], v11, s[40:43], s75 offen offset:0
  buffer_load_dwordx2 v[90:91], v11, s[40:43], s75 offen offset:1024
  buffer_load_dwordx2 v[92:93], v11, s[40:43], s75 offen offset:2048
  buffer_load_dwordx2 v[94:95], v11, s[40:43], s75 offen offset:3072
  s_cmp_ge_u32 s95, 11
  s_cbranch_scc1 L85
  buffer_load_dwordx2 v[96:97], v10, s[40:43], s76 offen offset:0
  buffer_load_dwordx2 v[98:99], v10, s[40:43], s76 offen offset:1024
  buffer_load_dwordx2 v[100:101], v10, s[40:43], s76 offen offset:2048
  buffer_load_dwordx2 v[102:103], v10, s[40:43], s76 offen offset:3072
  buffer_load_dwordx2 v[104:105], v11, s[40:43], s76 offen offset:0
  buffer_load_dwordx2 v[106:107], v11, s[40:43], s76 offen offset:1024
  buffer_load_dwordx2 v[108:109], v11, s[40:43], s76 offen offset:2048
  buffer_load_dwordx2 v[110:111], v11, s[40:43], s76 offen offset:3072
L85:
  s_setprio 0
  s_bitcmp1_b32 s65, 3
  s_cselect_b32 s72, 0xbe800000, 0
  v_lshl_add_u32 v5, v3, 8, s65
  v_cvt_f32_u32 v5, v5
  v_mul_f32 v5, 0x3a000000, v5
  v_add_u32 v7, 158720, v4
  v_add_u32 v8, 0, v2
  v_cvt_f32_u32 v8, v8
  v_mov_b32 v9, s72
  v_fmac_f32 v9, v8, v5
  v_mov_b32 v16, v9
  v_fmamk_f32 v17, v8, 0x3d000000, v9
  v_cos_f32 v18, v16
  v_cos_f32 v19, v17
  v_sin_f32 v20, v16
  v_sin_f32 v21, v17
  v_cvt_pk_bf16_f32 v64, v18, v19
  v_cvt_pk_bf16_f32 v68, v20, v21
  v_fmamk_f32 v16, v8, 0x3d800000, v9
  v_fmamk_f32 v17, v8, 0x3dc00000, v9
  v_cos_f32 v18, v16
  v_cos_f32 v19, v17
  v_sin_f32 v20, v16
  v_sin_f32 v21, v17
  v_cvt_pk_bf16_f32 v65, v18, v19
  v_cvt_pk_bf16_f32 v69, v20, v21
  v_fma_f32 v16, v8, 0.5, v9
  v_fmamk_f32 v17, v8, 0x3f080000, v9
  v_cos_f32 v18, v16
  v_cos_f32 v19, v17
  v_sin_f32 v20, v16
  v_sin_f32 v21, v17
  v_cvt_pk_bf16_f32 v66, v18, v19
  v_cvt_pk_bf16_f32 v70, v20, v21
  v_fmamk_f32 v16, v8, 0x3f100000, v9
  v_fmamk_f32 v17, v8, 0x3f180000, v9
  v_cos_f32 v18, v16
  v_cos_f32 v19, v17
  v_sin_f32 v20, v16
  v_sin_f32 v21, v17
  v_cvt_pk_bf16_f32 v67, v18, v19
  v_cvt_pk_bf16_f32 v71, v20, v21
  ds_write_b128 v7, v[64:67] offset:0
  ds_write_b128 v7, v[68:71] offset:1024
  v_add_u32 v8, 16, v2
  v_cvt_f32_u32 v8, v8
  v_mov_b32 v9, s72
  v_fmac_f32 v9, v8, v5
  v_mov_b32 v16, v9
  v_fmamk_f32 v17, v8, 0x3d000000, v9
  v_cos_f32 v18, v16
  v_cos_f32 v19, v17
  v_sin_f32 v20, v16
  v_sin_f32 v21, v17
  v_cvt_pk_bf16_f32 v72, v18, v19
  v_cvt_pk_bf16_f32 v76, v20, v21
  v_fmamk_f32 v16, v8, 0x3d800000, v9
  v_fmamk_f32 v17, v8, 0x3dc00000, v9
  v_cos_f32 v18, v16
  v_cos_f32 v19, v17
  v_sin_f32 v20, v16
  v_sin_f32 v21, v17
  v_cvt_pk_bf16_f32 v73, v18, v19
  v_cvt_pk_bf16_f32 v77, v20, v21
  v_fma_f32 v16, v8, 0.5, v9
  v_fmamk_f32 v17, v8, 0x3f080000, v9
  v_cos_f32 v18, v16
  v_cos_f32 v19, v17
  v_sin_f32 v20, v16
  v_sin_f32 v21, v17
  v_cvt_pk_bf16_f32 v74, v18, v19
  v_cvt_pk_bf16_f32 v78, v20, v21
  v_fmamk_f32 v16, v8, 0x3f100000, v9
  v_fmamk_f32 v17, v8, 0x3f180000, v9
  v_cos_f32 v18, v16
  v_cos_f32 v19, v17
  v_sin_f32 v20, v16
  v_sin_f32 v21, v17
  v_cvt_pk_bf16_f32 v75, v18, v19
  v_cvt_pk_bf16_f32 v79, v20, v21
  ds_write_b128 v7, v[72:75] offset:2048
  ds_write_b128 v7, v[76:79] offset:3072
  v_mov_b32 v5, 1
  s_mov_b64 exec, 1
  ds_add_u32 v0, v5 offset:88
  s_mov_b64 exec, -1
  s_setprio 2
  s_mov_b32 s52, s24
  s_and_b32 s53, s25, 0xffff
  s_mov_b32 s54, 256
  s_mov_b32 s55, 0x20000
  s_mov_b64 s[58:59], s[24:25]
  s_mov_b32 s74, 0x05040100
  s_mov_b32 s75, 0x07060302
  s_mul_i32 s78, s94, 43
  s_add_u32 s78, s78, s95
  s_lshl_b32 s78, s78, 12
  s_add_u32 s78, s78, 5767168
  s_waitcnt vmcnt(0)
  v_perm_b32 v24, v82, v80, s74
  v_perm_b32 v25, v86, v84, s74
  v_perm_b32 v26, v90, v88, s74
  v_perm_b32 v27, v94, v92, s74
  buffer_store_dwordx4 v[24:27], v4, s[48:51], s78 offen offset:0 sc1
  v_perm_b32 v28, v82, v80, s75
  v_perm_b32 v29, v86, v84, s75
  v_perm_b32 v30, v90, v88, s75
  v_perm_b32 v31, v94, v92, s75
  buffer_store_dwordx4 v[28:31], v4, s[48:51], s78 offen offset:1024 sc1
  v_perm_b32 v32, v83, v81, s74
  v_perm_b32 v33, v87, v85, s74
  v_perm_b32 v34, v91, v89, s74
  v_perm_b32 v35, v95, v93, s74
  buffer_store_dwordx4 v[32:35], v4, s[48:51], s78 offen offset:2048 sc1
  v_perm_b32 v36, v83, v81, s75
  v_perm_b32 v37, v87, v85, s75
  v_perm_b32 v38, v91, v89, s75
  v_perm_b32 v39, v95, v93, s75
  buffer_store_dwordx4 v[36:39], v4, s[48:51], s78 offen offset:3072 sc1
  s_cmp_ge_u32 s95, 11
  s_cbranch_scc1 L86
  s_add_u32 s78, s78, 131072
  v_perm_b32 v40, v98, v96, s74
  v_perm_b32 v41, v102, v100, s74
  v_perm_b32 v42, v106, v104, s74
  v_perm_b32 v43, v110, v108, s74
  buffer_store_dwordx4 v[40:43], v4, s[48:51], s78 offen offset:0 sc1
  v_perm_b32 v44, v98, v96, s75
  v_perm_b32 v45, v102, v100, s75
  v_perm_b32 v46, v106, v104, s75
  v_perm_b32 v47, v110, v108, s75
  buffer_store_dwordx4 v[44:47], v4, s[48:51], s78 offen offset:1024 sc1
  v_perm_b32 v48, v99, v97, s74
  v_perm_b32 v49, v103, v101, s74
  v_perm_b32 v50, v107, v105, s74
  v_perm_b32 v51, v111, v109, s74
  buffer_store_dwordx4 v[48:51], v4, s[48:51], s78 offen offset:2048 sc1
  v_perm_b32 v52, v99, v97, s75
  v_perm_b32 v53, v103, v101, s75
  v_perm_b32 v54, v107, v105, s75
  v_perm_b32 v55, v111, v109, s75
  buffer_store_dwordx4 v[52:55], v4, s[48:51], s78 offen offset:3072 sc1
L86:
  v_mov_b32 v112, -1
  v_mov_b32 v113, -1
  v_mov_b32 v114, -1
  v_mov_b32 v115, -1
  s_lshl_b32 s72, s67, 17
  s_lshl_b32 s73, s70, 10
  s_add_u32 s72, s72, s73
  s_add_u32 s72, s72, 3145728
  s_xor_b32 s73, s71, 1
  s_cmp_eq_u32 s67, 0
  s_cselect_b32 s73, s71, s73
  s_cmp_lg_u32 s71, 0
  s_cbranch_scc1 L87
  s_add_u32 s74, s72, 0
  buffer_store_dwordx4 v[112:115], v4, s[48:51], s74 offen sc1
  s_add_u32 s74, s72, 16384
  buffer_store_dwordx4 v[112:115], v4, s[48:51], s74 offen sc1
L87:
  s_cmp_lg_u32 s73, 0
  s_cbranch_scc1 L88
  s_add_u32 s74, s72, 8192
  buffer_store_dwordx4 v[112:115], v4, s[48:51], s74 offen sc1
  s_add_u32 s74, s72, 24576
  buffer_store_dwordx4 v[112:115], v4, s[48:51], s74 offen sc1
L88:
  s_branch Lh5
Lc1:
  s_mov_b32 s79, 0x400000
L3:
  ds_read_b32 v5, v0 offset:52
  s_waitcnt lgkmcnt(0)
  v_cmp_gt_u32 vcc, 4, v5
  s_cbranch_vccz L4
  s_sleep 1
  s_sub_u32 s79, s79, 1
  s_cbranch_scc0 L3
L4:
  ds_read_b128 a[0:3], v8 offset:0
  ds_read_b128 a[4:7], v9 offset:0
  ds_read_b128 a[8:11], v8 offset:256
  ds_read_b128 a[12:15], v9 offset:256
  ds_read_b128 a[16:19], v8 offset:512
  ds_read_b128 a[20:23], v9 offset:512
  ds_read_b128 a[24:27], v8 offset:768
  ds_read_b128 a[28:31], v9 offset:768
  ds_read_b128 v[16:19], v12
  ds_read_b128 v[20:23], v12 offset:64
  s_cmp_eq_u32 s64, 1
  s_cbranch_scc1 L7
  s_cmp_eq_u32 s64, 2
  s_cbranch_scc1 L8
  s_cmp_eq_u32 s64, 3
  s_cbranch_scc1 L9
L6:
  s_waitcnt lgkmcnt(8)
  v_mfma_f32_16x16x32_bf16 v[96:99], a[0:3], v[64:67], 0
  ds_read_b128 a[32:35], v10 offset:0
  v_mfma_f32_16x16x32_bf16 v[104:107], a[0:3], v[80:83], 0
  v_mfma_f32_16x16x32_bf16 v[96:99], a[4:7], v[68:71], v[96:99]
  ds_read_b128 a[36:39], v11 offset:0
  v_mfma_f32_16x16x32_bf16 v[104:107], a[4:7], v[84:87], v[104:107]
  s_waitcnt lgkmcnt(8)
  v_mfma_f32_16x16x32_bf16 v[96:99], a[8:11], v[64:67], v[96:99]
  ds_read_b128 a[40:43], v10 offset:256
  v_mfma_f32_16x16x32_bf16 v[104:107], a[8:11], v[80:83], v[104:107]
  v_mfma_f32_16x16x32_bf16 v[96:99], a[12:15], v[68:71], v[96:99]
  ds_read_b128 a[44:47], v11 offset:256
  v_mfma_f32_16x16x32_bf16 v[104:107], a[12:15], v[84:87], v[104:107]
  s_waitcnt lgkmcnt(8)
  v_mfma_f32_16x16x32_bf16 v[96:99], a[16:19], v[64:67], v[96:99]
  ds_read_b128 a[0:3], v10 offset:512
  v_mfma_f32_16x16x32_bf16 v[104:107], a[16:19], v[80:83], v[104:107]
  v_mfma_f32_16x16x32_bf16 v[96:99], a[20:23], v[68:71], v[96:99]
  ds_read_b128 a[4:7], v11 offset:512
  v_mfma_f32_16x16x32_bf16 v[104:107], a[20:23], v[84:87], v[104:107]
  s_waitcnt lgkmcnt(8)
  v_mfma_f32_16x16x32_bf16 v[96:99], a[24:27], v[64:67], v[96:99]
  ds_read_b128 a[8:11], v10 offset:768
  v_mfma_f32_16x16x32_bf16 v[104:107], a[24:27], v[80:83], v[104:107]
  v_mfma_f32_16x16x32_bf16 v[96:99], a[28:31], v[68:71], v[96:99]
  ds_read_b128 a[12:15], v11 offset:768
  v_mfma_f32_16x16x32_bf16 v[104:107], a[28:31], v[84:87], v[104:107]
  s_waitcnt lgkmcnt(6)
  v_mfma_f32_16x16x32_bf16 v[96:99], a[32:35], v[72:75], v[96:99]
  ds_read_b128 a[16:19], v8 offset:16384
  v_mfma_f32_16x16x32_bf16 v[104:107], a[32:35], v[88:91], v[104:107]
  v_mfma_f32_16x16x32_bf16 v[96:99], a[36:39], v[76:79], v[96:99]
  ds_read_b128 a[20:23], v9 offset:16384
  v_mfma_f32_16x16x32_bf16 v[104:107], a[36:39], v[92:95], v[104:107]
  s_waitcnt lgkmcnt(6)
  v_mfma_f32_16x16x32_bf16 v[96:99], a[40:43], v[72:75], v[96:99]
  ds_read_b128 a[24:27], v8 offset:16640
  v_mfma_f32_16x16x32_bf16 v[104:107], a[40:43], v[88:91], v[104:107]
  v_mfma_f32_16x16x32_bf16 v[96:99], a[44:47], v[76:79], v[96:99]
  ds_read_b128 a[28:31], v9 offset:16640
  v_mfma_f32_16x16x32_bf16 v[104:107], a[44:47], v[92:95], v[104:107]
  s_waitcnt lgkmcnt(6)
  v_mfma_f32_16x16x32_bf16 v[96:99], a[0:3], v[72:75], v[96:99]
  ds_read_b128 a[32:35], v8 offset:16896
  v_mfma_f32_16x16x32_bf16 v[104:107], a[0:3], v[88:91], v[104:107]
  v_mfma_f32_16x16x32_bf16 v[96:99], a[4:7], v[76:79], v[96:99]
  ds_read_b128 a[36:39], v9 offset:16896
  v_mfma_f32_16x16x32_bf16 v[104:107], a[4:7], v[92:95], v[104:107]
  s_waitcnt lgkmcnt(6)
  v_mfma_f32_16x16x32_bf16 v[96:99], a[8:11], v[72:75], v[96:99]
  ds_read_b128 a[40:43], v8 offset:17152
  v_mfma_f32_16x16x32_bf16 v[104:107], a[8:11], v[88:91], v[104:107]
  ds_read_b32 v15, v0 offset:88
  v_mfma_f32_16x16x32_bf16 v[96:99], a[12:15], v[76:79], v[96:99]
  ds_read_b128 a[44:47], v9 offset:17152
  v_mfma_f32_16x16x32_bf16 v[104:107], a[12:15], v[92:95], v[104:107]
  s_waitcnt lgkmcnt(7)
  v_mfma_f32_16x16x32_bf16 v[112:115], a[16:19], v[64:67], 0
  ds_read_b128 a[0:3], v10 offset:16384
  v_mfma_f32_16x16x32_bf16 v[120:123], a[16:19], v[80:83], 0
  v_mfma_f32_16x16x32_bf16 v[112:115], a[20:23], v[68:71], v[112:115]
  ds_read_b128 a[4:7], v11 offset:16384
  v_mfma_f32_16x16x32_bf16 v[120:123], a[20:23], v[84:87], v[120:123]
  s_waitcnt lgkmcnt(7)
  v_mfma_f32_16x16x32_bf16 v[112:115], a[24:27], v[64:67], v[112:115]
  ds_read_b128 a[8:11], v10 offset:16640
  v_mul_f32 v96, v96, v16
  v_mfma_f32_16x16x32_bf16 v[120:123], a[24:27], v[80:83], v[120:123]
  s_waitcnt lgkmcnt(4)
  v_cmp_gt_u32 vcc, 1, v15
  s_cbranch_vccz L10
  s_mov_b32 s79, 0x400000
L11:
  ds_read_b32 v15, v0 offset:88
  s_waitcnt lgkmcnt(0)
  v_cmp_gt_u32 vcc, 1, v15
  s_cbranch_vccz L12
  s_sleep 1
  s_sub_u32 s79, s79, 1
  s_cbranch_scc0 L11
L12:
L10:
  ds_read_b128 a[64:67], v14 offset:0
  v_mul_f32 v97, v97, v17
  v_mfma_f32_16x16x32_bf16 v[112:115], a[28:31], v[68:71], v[112:115]
  ds_read_b128 a[12:15], v11 offset:16640
  v_mul_f32 v98, v98, v18
  v_mfma_f32_16x16x32_bf16 v[120:123], a[28:31], v[84:87], v[120:123]
  ds_read_b128 a[68:71], v14 offset:1024
  v_mul_f32 v99, v99, v19
  v_mfma_f32_16x16x32_bf16 v[112:115], a[32:35], v[64:67], v[112:115]
  ds_read_b128 a[16:19], v10 offset:16896
  v_cvt_pk_bf16_f32 v24, v96, v97
  v_mfma_f32_16x16x32_bf16 v[120:123], a[32:35], v[80:83], v[120:123]
  ds_read_b128 a[72:75], v14 offset:2048
  v_cvt_pk_bf16_f32 v25, v98, v99
  v_mfma_f32_16x16x32_bf16 v[112:115], a[36:39], v[68:71], v[112:115]
  ds_read_b128 a[20:23], v11 offset:16896
  v_xor_b32 v48, s94, v24
  v_mfma_f32_16x16x32_bf16 v[120:123], a[36:39], v[84:87], v[120:123]
  ds_read_b128 a[76:79], v14 offset:3072
  v_xor_b32 v49, s94, v25
  s_waitcnt lgkmcnt(10)
  v_mfma_f32_16x16x32_bf16 v[112:115], a[40:43], v[64:67], v[112:115]
  ds_read_b128 a[24:27], v10 offset:17152
  v_mul_f32 v104, v104, v16
  v_mfma_f32_16x16x32_bf16 v[120:123], a[40:43], v[80:83], v[120:123]
  v_mul_f32 v105, v105, v17
  v_mfma_f32_16x16x32_bf16 v[112:115], a[44:47], v[68:71], v[112:115]
  ds_read_b128 a[28:31], v11 offset:17152
  v_mul_f32 v106, v106, v18
  v_mfma_f32_16x16x32_bf16 v[120:123], a[44:47], v[84:87], v[120:123]
  v_mul_f32 v107, v107, v19
  s_waitcnt lgkmcnt(10)
  v_mfma_f32_16x16x32_bf16 v[112:115], a[0:3], v[72:75], v[112:115]
  v_cvt_pk_bf16_f32 v28, v104, v105
  v_mfma_f32_16x16x32_bf16 v[120:123], a[0:3], v[88:91], v[120:123]
  v_cvt_pk_bf16_f32 v29, v106, v107
  v_mfma_f32_16x16x32_bf16 v[112:115], a[4:7], v[76:79], v[112:115]
  v_xor_b32 v52, s95, v28
  v_mfma_f32_16x16x32_bf16 v[120:123], a[4:7], v[92:95], v[120:123]
  v_xor_b32 v53, s95, v29
  s_waitcnt lgkmcnt(7)
  v_mfma_f32_16x16x32_bf16 v[112:115], a[8:11], v[72:75], v[112:115]
  v_mfma_f32_16x16x32_bf16 v[120:123], a[8:11], v[88:91], v[120:123]
  v_mfma_f32_16x16x32_bf16 v[112:115], a[12:15], v[76:79], v[112:115]
  v_mfma_f32_16x16x32_bf16 v[120:123], a[12:15], v[92:95], v[120:123]
  s_waitcnt lgkmcnt(3)
  v_mfma_f32_16x16x32_bf16 v[112:115], a[16:19], v[72:75], v[112:115]
  v_mfma_f32_16x16x32_bf16 v[120:123], a[16:19], v[88:91], v[120:123]
  v_mfma_f32_16x16x32_bf16 v[112:115], a[20:23], v[76:79], v[112:115]
  v_mfma_f32_16x16x32_bf16 v[120:123], a[20:23], v[92:95], v[120:123]
  s_waitcnt lgkmcnt(0)
  v_mov_b32 v5, 1
  s_mov_b64 exec, 1
  ds_add_u32 v0, v5 offset:56
  s_mov_b64 exec, -1
  v_mfma_f32_16x16x32_bf16 v[112:115], a[24:27], v[72:75], v[112:115]
  v_mfma_f32_16x16x32_bf16 v[120:123], a[24:27], v[88:91], v[120:123]
  v_mfma_f32_16x16x32_bf16 v[112:115], a[28:31], v[76:79], v[112:115]
  v_mfma_f32_16x16x32_bf16 v[120:123], a[28:31], v[92:95], v[120:123]
  s_nop 6
  v_mul_f32 v112, v112, v20
  v_mul_f32 v113, v113, v21
  v_mul_f32 v114, v114, v22
  v_mul_f32 v115, v115, v23
  v_cvt_pk_bf16_f32 v26, v112, v113
  v_cvt_pk_bf16_f32 v27, v114, v115
  v_xor_b32 v50, s94, v26
  v_xor_b32 v51, s94, v27
  v_mul_f32 v120, v120, v20
  v_mul_f32 v121, v121, v21
  v_mul_f32 v122, v122, v22
  v_mul_f32 v123, v123, v23
  v_cvt_pk_bf16_f32 v30, v120, v121
  v_cvt_pk_bf16_f32 v31, v122, v123
  v_xor_b32 v54, s95, v30
  v_xor_b32 v55, s95, v31
  s_branch L5
L7:
  s_waitcnt lgkmcnt(8)
  v_mfma_f32_16x16x32_bf16 v[96:99], a[0:3], v[64:67], 0
  ds_read_b128 a[32:35], v10 offset:0
  v_mfma_f32_16x16x32_bf16 v[104:107], a[0:3], v[80:83], 0
  v_mfma_f32_16x16x32_bf16 v[96:99], a[4:7], v[68:71], v[96:99]
  ds_read_b128 a[36:39], v11 offset:0
  v_mfma_f32_16x16x32_bf16 v[104:107], a[4:7], v[84:87], v[104:107]
  s_waitcnt lgkmcnt(8)
  v_mfma_f32_16x16x32_bf16 v[108:111], a[8:11], v[64:67], 0
  ds_read_b128 a[40:43], v10 offset:256
  v_mfma_f32_16x16x32_bf16 v[96:99], a[8:11], v[80:83], v[96:99]
  v_mfma_f32_16x16x32_bf16 v[108:111], a[12:15], v[68:71], v[108:111]
  ds_read_b128 a[44:47], v11 offset:256
  v_mfma_f32_16x16x32_bf16 v[96:99], a[12:15], v[84:87], v[96:99]
  s_waitcnt lgkmcnt(8)
  v_mfma_f32_16x16x32_bf16 v[100:103], a[16:19], v[64:67], 0
  ds_read_b128 a[0:3], v10 offset:512
  v_mfma_f32_16x16x32_bf16 v[108:111], a[16:19], v[80:83], v[108:111]
  v_mfma_f32_16x16x32_bf16 v[100:103], a[20:23], v[68:71], v[100:103]
  ds_read_b128 a[4:7], v11 offset:512
  v_mfma_f32_16x16x32_bf16 v[108:111], a[20:23], v[84:87], v[108:111]
  s_waitcnt lgkmcnt(8)
  v_mfma_f32_16x16x32_bf16 v[104:107], a[24:27], v[64:67], v[104:107]
  ds_read_b128 a[8:11], v10 offset:768
  v_mfma_f32_16x16x32_bf16 v[100:103], a[24:27], v[80:83], v[100:103]
  v_mfma_f32_16x16x32_bf16 v[104:107], a[28:31], v[68:71], v[104:107]
  ds_read_b128 a[12:15], v11 offset:768
  v_mfma_f32_16x16x32_bf16 v[100:103], a[28:31], v[84:87], v[100:103]
  s_waitcnt lgkmcnt(6)
  v_mfma_f32_16x16x32_bf16 v[96:99], a[32:35], v[72:75], v[96:99]
  ds_read_b128 a[16:19], v8 offset:16384
  v_mfma_f32_16x16x32_bf16 v[104:107], a[32:35], v[88:91], v[104:107]
  v_mfma_f32_16x16x32_bf16 v[96:99], a[36:39], v[76:79], v[96:99]
  ds_read_b128 a[20:23], v9 offset:16384
  v_mfma_f32_16x16x32_bf16 v[104:107], a[36:39], v[92:95], v[104:107]
  s_waitcnt lgkmcnt(6)
  v_mfma_f32_16x16x32_bf16 v[108:111], a[40:43], v[72:75], v[108:111]
  ds_read_b128 a[24:27], v8 offset:16640
  v_mfma_f32_16x16x32_bf16 v[96:99], a[40:43], v[88:91], v[96:99]
  v_mfma_f32_16x16x32_bf16 v[108:111], a[44:47], v[76:79], v[108:111]
  ds_read_b128 a[28:31], v9 offset:16640
  v_mfma_f32_16x16x32_bf16 v[96:99], a[44:47], v[92:95], v[96:99]
  s_waitcnt lgkmcnt(6)
  v_mfma_f32_16x16x32_bf16 v[100:103], a[0:3], v[72:75], v[100:103]
  ds_read_b128 a[32:35], v8 offset:16896
  v_mfma_f32_16x16x32_bf16 v[108:111], a[0:3], v[88:91], v[108:111]
  v_mfma_f32_16x16x32_bf16 v[100:103], a[4:7], v[76:79], v[100:103]
  ds_read_b128 a[36:39], v9 offset:16896
  v_mfma_f32_16x16x32_bf16 v[108:111], a[4:7], v[92:95], v[108:111]
  s_waitcnt lgkmcnt(6)
  v_mfma_f32_16x16x32_bf16 v[104:107], a[8:11], v[72:75], v[104:107]
  ds_read_b128 a[40:43], v8 offset:17152
  v_mfma_f32_16x16x32_bf16 v[100:103], a[8:11], v[88:91], v[100:103]
  ds_read_b32 v15, v0 offset:88
  v_mfma_f32_16x16x32_bf16 v[104:107], a[12:15], v[76:79], v[104:107]
  ds_read_b128 a[44:47], v9 offset:17152
  v_mfma_f32_16x16x32_bf16 v[100:103], a[12:15], v[92:95], v[100:103]
  s_waitcnt lgkmcnt(7)
  v_mfma_f32_16x16x32_bf16 v[112:115], a[16:19], v[64:67], 0
  ds_read_b128 a[0:3], v10 offset:16384
  v_mfma_f32_16x16x32_bf16 v[120:123], a[16:19], v[80:83], 0
  v_mfma_f32_16x16x32_bf16 v[112:115], a[20:23], v[68:71], v[112:115]
  ds_read_b128 a[4:7], v11 offset:16384
  v_mfma_f32_16x16x32_bf16 v[120:123], a[20:23], v[84:87], v[120:123]
  s_waitcnt lgkmcnt(7)
  v_mfma_f32_16x16x32_bf16 v[124:127], a[24:27], v[64:67], 0
  ds_read_b128 a[8:11], v10 offset:16640
  v_sub_f32 v96, v96, v100
  v_mfma_f32_16x16x32_bf16 v[112:115], a[24:27], v[80:83], v[112:115]
  s_waitcnt lgkmcnt(4)
  v_cmp_gt_u32 vcc, 1, v15
  s_cbranch_vccz L13
  s_mov_b32 s79, 0x400000
L14:
  ds_read_b32 v15, v0 offset:88
  s_waitcnt lgkmcnt(0)
  v_cmp_gt_u32 vcc, 1, v15
  s_cbranch_vccz L15
  s_sleep 1
  s_sub_u32 s79, s79, 1
  s_cbranch_scc0 L14
L15:
L13:
  ds_read_b128 a[64:67], v14 offset:0
  v_sub_f32 v97, v97, v101
  v_mfma_f32_16x16x32_bf16 v[124:127], a[28:31], v[68:71], v[124:127]
  ds_read_b128 a[12:15], v11 offset:16640
  v_sub_f32 v98, v98, v102
  v_mfma_f32_16x16x32_bf16 v[112:115], a[28:31], v[84:87], v[112:115]
  ds_read_b128 a[68:71], v14 offset:1024
  v_sub_f32 v99, v99, v103
  v_mfma_f32_16x16x32_bf16 v[116:119], a[32:35], v[64:67], 0
  ds_read_b128 a[16:19], v10 offset:16896
  v_mul_f32 v96, v96, v16
  v_mfma_f32_16x16x32_bf16 v[124:127], a[32:35], v[80:83], v[124:127]
  ds_read_b128 a[72:75], v14 offset:2048
  v_mul_f32 v97, v97, v17
  v_mfma_f32_16x16x32_bf16 v[116:119], a[36:39], v[68:71], v[116:119]
  ds_read_b128 a[20:23], v11 offset:16896
  v_mul_f32 v98, v98, v18
  v_mfma_f32_16x16x32_bf16 v[124:127], a[36:39], v[84:87], v[124:127]
  ds_read_b128 a[76:79], v14 offset:3072
  v_mul_f32 v99, v99, v19
  s_waitcnt lgkmcnt(10)
  v_mfma_f32_16x16x32_bf16 v[120:123], a[40:43], v[64:67], v[120:123]
  ds_read_b128 a[24:27], v10 offset:17152
  v_cvt_pk_bf16_f32 v24, v96, v97
  v_mfma_f32_16x16x32_bf16 v[116:119], a[40:43], v[80:83], v[116:119]
  v_cvt_pk_bf16_f32 v25, v98, v99
  v_mfma_f32_16x16x32_bf16 v[120:123], a[44:47], v[68:71], v[120:123]
  ds_read_b128 a[28:31], v11 offset:17152
  v_xor_b32 v48, s94, v24
  v_mfma_f32_16x16x32_bf16 v[116:119], a[44:47], v[84:87], v[116:119]
  v_xor_b32 v49, s94, v25
  s_waitcnt lgkmcnt(10)
  v_mfma_f32_16x16x32_bf16 v[112:115], a[0:3], v[72:75], v[112:115]
  v_sub_f32 v104, v104, v108
  v_mfma_f32_16x16x32_bf16 v[120:123], a[0:3], v[88:91], v[120:123]
  v_sub_f32 v105, v105, v109
  v_mfma_f32_16x16x32_bf16 v[112:115], a[4:7], v[76:79], v[112:115]
  v_sub_f32 v106, v106, v110
  v_mfma_f32_16x16x32_bf16 v[120:123], a[4:7], v[92:95], v[120:123]
  v_sub_f32 v107, v107, v111
  s_waitcnt lgkmcnt(7)
  v_mfma_f32_16x16x32_bf16 v[124:127], a[8:11], v[72:75], v[124:127]
  v_mul_f32 v104, v104, v16
  v_mfma_f32_16x16x32_bf16 v[112:115], a[8:11], v[88:91], v[112:115]
  v_mul_f32 v105, v105, v17
  v_mfma_f32_16x16x32_bf16 v[124:127], a[12:15], v[76:79], v[124:127]
  v_mul_f32 v106, v106, v18
  v_mfma_f32_16x16x32_bf16 v[112:115], a[12:15], v[92:95], v[112:115]
  v_mul_f32 v107, v107, v19
  s_waitcnt lgkmcnt(3)
  v_mfma_f32_16x16x32_bf16 v[116:119], a[16:19], v[72:75], v[116:119]
  v_cvt_pk_bf16_f32 v28, v104, v105
  v_mfma_f32_16x16x32_bf16 v[124:127], a[16:19], v[88:91], v[124:127]
  v_cvt_pk_bf16_f32 v29, v106, v107
  v_mfma_f32_16x16x32_bf16 v[116:119], a[20:23], v[76:79], v[116:119]
  v_xor_b32 v52, s95, v28
  v_mfma_f32_16x16x32_bf16 v[124:127], a[20:23], v[92:95], v[124:127]
  v_xor_b32 v53, s95, v29
  s_waitcnt lgkmcnt(0)
  v_mov_b32 v5, 1
  s_mov_b64 exec, 1
  ds_add_u32 v0, v5 offset:56
  s_mov_b64 exec, -1
  v_mfma_f32_16x16x32_bf16 v[120:123], a[24:27], v[72:75], v[120:123]
  v_mfma_f32_16x16x32_bf16 v[116:119], a[24:27], v[88:91], v[116:119]
  v_mfma_f32_16x16x32_bf16 v[120:123], a[28:31], v[76:79], v[120:123]
  v_mfma_f32_16x16x32_bf16 v[116:119], a[28:31], v[92:95], v[116:119]
  s_nop 7
  v_sub_f32 v112, v112, v116
  v_sub_f32 v113, v113, v117
  v_sub_f32 v114, v114, v118
  v_sub_f32 v115, v115, v119
  v_mul_f32 v112, v112, v20
  v_mul_f32 v113, v113, v21
  v_mul_f32 v114, v114, v22
  v_mul_f32 v115, v115, v23
  v_cvt_pk_bf16_f32 v26, v112, v113
  v_cvt_pk_bf16_f32 v27, v114, v115
  v_xor_b32 v50, s94, v26
  v_xor_b32 v51, s94, v27
  v_sub_f32 v120, v120, v124
  v_sub_f32 v121, v121, v125
  v_sub_f32 v122, v122, v126
  v_sub_f32 v123, v123, v127
  v_mul_f32 v120, v120, v20
  v_mul_f32 v121, v121, v21
  v_mul_f32 v122, v122, v22
  v_mul_f32 v123, v123, v23
  v_cvt_pk_bf16_f32 v30, v120, v121
  v_cvt_pk_bf16_f32 v31, v122, v123
  v_xor_b32 v54, s95, v30
  v_xor_b32 v55, s95, v31
  s_branch L5
L8:
  s_waitcnt lgkmcnt(8)
  v_mfma_f32_16x16x32_bf16 v[96:99], a[0:3], v[64:67], 0
  ds_read_b128 a[32:35], v10 offset:0
  v_mfma_f32_16x16x32_bf16 v[104:107], a[0:3], v[80:83], 0
  v_mfma_f32_16x16x32_bf16 v[96:99], a[4:7], v[68:71], v[96:99]
  ds_read_b128 a[36:39], v11 offset:0
  v_mfma_f32_16x16x32_bf16 v[104:107], a[4:7], v[84:87], v[104:107]
  s_waitcnt lgkmcnt(8)
  v_mfma_f32_16x16x32_bf16 v[100:103], a[8:11], v[64:67], 0
  ds_read_b128 a[40:43], v10 offset:256
  v_mfma_f32_16x16x32_bf16 v[108:111], a[8:11], v[80:83], 0
  v_mfma_f32_16x16x32_bf16 v[100:103], a[12:15], v[68:71], v[100:103]
  ds_read_b128 a[44:47], v11 offset:256
  v_mfma_f32_16x16x32_bf16 v[108:111], a[12:15], v[84:87], v[108:111]
  s_waitcnt lgkmcnt(8)
  v_mfma_f32_16x16x32_bf16 v[96:99], a[16:19], v[64:67], v[96:99]
  ds_read_b128 a[0:3], v10 offset:512
  v_mfma_f32_16x16x32_bf16 v[104:107], a[16:19], v[80:83], v[104:107]
  v_mfma_f32_16x16x32_bf16 v[96:99], a[20:23], v[68:71], v[96:99]
  ds_read_b128 a[4:7], v11 offset:512
  v_mfma_f32_16x16x32_bf16 v[104:107], a[20:23], v[84:87], v[104:107]
  s_waitcnt lgkmcnt(8)
  v_mfma_f32_16x16x32_bf16 v[100:103], a[24:27], v[64:67], v[100:103]
  ds_read_b128 a[8:11], v10 offset:768
  v_mfma_f32_16x16x32_bf16 v[108:111], a[24:27], v[80:83], v[108:111]
  v_mfma_f32_16x16x32_bf16 v[100:103], a[28:31], v[68:71], v[100:103]
  ds_read_b128 a[12:15], v11 offset:768
  v_mfma_f32_16x16x32_bf16 v[108:111], a[28:31], v[84:87], v[108:111]
  s_waitcnt lgkmcnt(6)
  v_mfma_f32_16x16x32_bf16 v[96:99], a[32:35], v[72:75], v[96:99]
  ds_read_b128 a[16:19], v8 offset:16384
  v_mfma_f32_16x16x32_bf16 v[104:107], a[32:35], v[88:91], v[104:107]
  v_mfma_f32_16x16x32_bf16 v[96:99], a[36:39], v[76:79], v[96:99]
  ds_read_b128 a[20:23], v9 offset:16384
  v_mfma_f32_16x16x32_bf16 v[104:107], a[36:39], v[92:95], v[104:107]
  s_waitcnt lgkmcnt(6)
  v_mfma_f32_16x16x32_bf16 v[100:103], a[40:43], v[72:75], v[100:103]
  ds_read_b128 a[24:27], v8 offset:16640
  v_mfma_f32_16x16x32_bf16 v[108:111], a[40:43], v[88:91], v[108:111]
  v_mfma_f32_16x16x32_bf16 v[100:103], a[44:47], v[76:79], v[100:103]
  ds_read_b128 a[28:31], v9 offset:16640
  v_mfma_f32_16x16x32_bf16 v[108:111], a[44:47], v[92:95], v[108:111]
  s_waitcnt lgkmcnt(6)
  v_mfma_f32_16x16x32_bf16 v[96:99], a[0:3], v[72:75], v[96:99]
  ds_read_b128 a[32:35], v8 offset:16896
  v_mfma_f32_16x16x32_bf16 v[104:107], a[0:3], v[88:91], v[104:107]
  v_mfma_f32_16x16x32_bf16 v[96:99], a[4:7], v[76:79], v[96:99]
  ds_read_b128 a[36:39], v9 offset:16896
  v_mfma_f32_16x16x32_bf16 v[104:107], a[4:7], v[92:95], v[104:107]
  s_waitcnt lgkmcnt(6)
  v_mfma_f32_16x16x32_bf16 v[100:103], a[8:11], v[72:75], v[100:103]
  ds_read_b128 a[40:43], v8 offset:17152
  v_mfma_f32_16x16x32_bf16 v[108:111], a[8:11], v[88:91], v[108:111]
  ds_read_b32 v15, v0 offset:88
  v_mfma_f32_16x16x32_bf16 v[100:103], a[12:15], v[76:79], v[100:103]
  ds_read_b128 a[44:47], v9 offset:17152
  v_mfma_f32_16x16x32_bf16 v[108:111], a[12:15], v[92:95], v[108:111]
  s_waitcnt lgkmcnt(7)
  v_mfma_f32_16x16x32_bf16 v[112:115], a[16:19], v[64:67], 0
  ds_read_b128 a[0:3], v10 offset:16384
  v_mfma_f32_16x16x32_bf16 v[120:123], a[16:19], v[80:83], 0
  v_mfma_f32_16x16x32_bf16 v[112:115], a[20:23], v[68:71], v[112:115]
  ds_read_b128 a[4:7], v11 offset:16384
  v_mfma_f32_16x16x32_bf16 v[120:123], a[20:23], v[84:87], v[120:123]
  s_waitcnt lgkmcnt(7)
  v_mfma_f32_16x16x32_bf16 v[116:119], a[24:27], v[64:67], 0
  ds_read_b128 a[8:11], v10 offset:16640
  v_sub_f32 v96, v96, v100
  v_mfma_f32_16x16x32_bf16 v[124:127], a[24:27], v[80:83], 0
  s_waitcnt lgkmcnt(4)
  v_cmp_gt_u32 vcc, 1, v15
  s_cbranch_vccz L16
  s_mov_b32 s79, 0x400000
L17:
  ds_read_b32 v15, v0 offset:88
  s_waitcnt lgkmcnt(0)
  v_cmp_gt_u32 vcc, 1, v15
  s_cbranch_vccz L18
  s_sleep 1
  s_sub_u32 s79, s79, 1
  s_cbranch_scc0 L17
L18:
L16:
  ds_read_b128 a[64:67], v14 offset:0
  v_sub_f32 v97, v97, v101
  v_mfma_f32_16x16x32_bf16 v[116:119], a[28:31], v[68:71], v[116:119]
  ds_read_b128 a[12:15], v11 offset:16640
  v_sub_f32 v98, v98, v102
  v_mfma_f32_16x16x32_bf16 v[124:127], a[28:31], v[84:87], v[124:127]
  ds_read_b128 a[68:71], v14 offset:1024
  v_sub_f32 v99, v99, v103
  v_mfma_f32_16x16x32_bf16 v[112:115], a[32:35], v[64:67], v[112:115]
  ds_read_b128 a[16:19], v10 offset:16896
  v_mul_f32 v96, v96, v16
  v_mfma_f32_16x16x32_bf16 v[120:123], a[32:35], v[80:83], v[120:123]
  ds_read_b128 a[72:75], v14 offset:2048
  v_mul_f32 v97, v97, v17
  v_mfma_f32_16x16x32_bf16 v[112:115], a[36:39], v[68:71], v[112:115]
  ds_read_b128 a[20:23], v11 offset:16896
  v_mul_f32 v98, v98, v18
  v_mfma_f32_16x16x32_bf16 v[120:123], a[36:39], v[84:87], v[120:123]
  ds_read_b128 a[76:79], v14 offset:3072
  v_mul_f32 v99, v99, v19
  s_waitcnt lgkmcnt(10)
  v_mfma_f32_16x16x32_bf16 v[116:119], a[40:43], v[64:67], v[116:119]
  ds_read_b128 a[24:27], v10 offset:17152
  v_cvt_pk_bf16_f32 v24, v96, v97
  v_mfma_f32_16x16x32_bf16 v[124:127], a[40:43], v[80:83], v[124:127]
  v_cvt_pk_bf16_f32 v25, v98, v99
  v_mfma_f32_16x16x32_bf16 v[116:119], a[44:47], v[68:71], v[116:119]
  ds_read_b128 a[28:31], v11 offset:17152
  v_xor_b32 v48, s94, v24
  v_mfma_f32_16x16x32_bf16 v[124:127], a[44:47], v[84:87], v[124:127]
  v_xor_b32 v49, s94, v25
  s_waitcnt lgkmcnt(10)
  v_mfma_f32_16x16x32_bf16 v[112:115], a[0:3], v[72:75], v[112:115]
  v_sub_f32 v104, v104, v108
  v_mfma_f32_16x16x32_bf16 v[120:123], a[0:3], v[88:91], v[120:123]
  v_sub_f32 v105, v105, v109
  v_mfma_f32_16x16x32_bf16 v[112:115], a[4:7], v[76:79], v[112:115]
  v_sub_f32 v106, v106, v110
  v_mfma_f32_16x16x32_bf16 v[120:123], a[4:7], v[92:95], v[120:123]
  v_sub_f32 v107, v107, v111
  s_waitcnt lgkmcnt(7)
  v_mfma_f32_16x16x32_bf16 v[116:119], a[8:11], v[72:75], v[116:119]
  v_mul_f32 v104, v104, v16
  v_mfma_f32_16x16x32_bf16 v[124:127], a[8:11], v[88:91], v[124:127]
  v_mul_f32 v105, v105, v17
  v_mfma_f32_16x16x32_bf16 v[116:119], a[12:15], v[76:79], v[116:119]
  v_mul_f32 v106, v106, v18
  v_mfma_f32_16x16x32_bf16 v[124:127], a[12:15], v[92:95], v[124:127]
  v_mul_f32 v107, v107, v19
  s_waitcnt lgkmcnt(3)
  v_mfma_f32_16x16x32_bf16 v[112:115], a[16:19], v[72:75], v[112:115]
  v_cvt_pk_bf16_f32 v28, v104, v105
  v_mfma_f32_16x16x32_bf16 v[120:123], a[16:19], v[88:91], v[120:123]
  v_cvt_pk_bf16_f32 v29, v106, v107
  v_mfma_f32_16x16x32_bf16 v[112:115], a[20:23], v[76:79], v[112:115]
  v_xor_b32 v52, s95, v28
  v_mfma_f32_16x16x32_bf16 v[120:123], a[20:23], v[92:95], v[120:123]
  v_xor_b32 v53, s95, v29
  s_waitcnt lgkmcnt(0)
  v_mov_b32 v5, 1
  s_mov_b64 exec, 1
  ds_add_u32 v0, v5 offset:56
  s_mov_b64 exec, -1
  v_mfma_f32_16x16x32_bf16 v[116:119], a[24:27], v[72:75], v[116:119]
  v_mfma_f32_16x16x32_bf16 v[124:127], a[24:27], v[88:91], v[124:127]
  v_mfma_f32_16x16x32_bf16 v[116:119], a[28:31], v[76:79], v[116:119]
  v_mfma_f32_16x16x32_bf16 v[124:127], a[28:31], v[92:95], v[124:127]
  s_nop 6
  v_sub_f32 v112, v112, v116
  v_sub_f32 v113, v113, v117
  v_sub_f32 v114, v114, v118
  v_sub_f32 v115, v115, v119
  v_mul_f32 v112, v112, v20
  v_mul_f32 v113, v113, v21
  v_mul_f32 v114, v114, v22
  v_mul_f32 v115, v115, v23
  v_cvt_pk_bf16_f32 v26, v112, v113
  v_cvt_pk_bf16_f32 v27, v114, v115
  v_xor_b32 v50, s94, v26
  v_xor_b32 v51, s94, v27
  v_sub_f32 v120, v120, v124
  v_sub_f32 v121, v121, v125
  v_sub_f32 v122, v122, v126
  v_sub_f32 v123, v123, v127
  v_mul_f32 v120, v120, v20
  v_mul_f32 v121, v121, v21
  v_mul_f32 v122, v122, v22
  v_mul_f32 v123, v123, v23
  v_cvt_pk_bf16_f32 v30, v120, v121
  v_cvt_pk_bf16_f32 v31, v122, v123
  v_xor_b32 v54, s95, v30
  v_xor_b32 v55, s95, v31
  s_branch L5
L9:
  s_waitcnt lgkmcnt(8)
  v_mfma_f32_16x16x32_bf16 v[96:99], a[0:3], v[64:67], 0
  ds_read_b128 a[32:35], v10 offset:0
  v_mfma_f32_16x16x32_bf16 v[104:107], a[0:3], v[80:83], 0
  v_mfma_f32_16x16x32_bf16 v[96:99], a[4:7], v[68:71], v[96:99]
  ds_read_b128 a[36:39], v11 offset:0
  v_mfma_f32_16x16x32_bf16 v[104:107], a[4:7], v[84:87], v[104:107]
  s_waitcnt lgkmcnt(8)
  v_mfma_f32_16x16x32_bf16 v[104:107], a[8:11], v[64:67], v[104:107]
  ds_read_b128 a[40:43], v10 offset:256
  v_mfma_f32_16x16x32_bf16 v[100:103], a[8:11], v[80:83], 0
  v_mfma_f32_16x16x32_bf16 v[104:107], a[12:15], v[68:71], v[104:107]
  ds_read_b128 a[44:47], v11 offset:256
  v_mfma_f32_16x16x32_bf16 v[100:103], a[12:15], v[84:87], v[100:103]
  s_waitcnt lgkmcnt(8)
  v_mfma_f32_16x16x32_bf16 v[100:103], a[16:19], v[64:67], v[100:103]
  ds_read_b128 a[0:3], v10 offset:512
  v_mfma_f32_16x16x32_bf16 v[108:111], a[16:19], v[80:83], 0
  v_mfma_f32_16x16x32_bf16 v[100:103], a[20:23], v[68:71], v[100:103]
  ds_read_b128 a[4:7], v11 offset:512
  v_mfma_f32_16x16x32_bf16 v[108:111], a[20:23], v[84:87], v[108:111]
  s_waitcnt lgkmcnt(8)
  v_mfma_f32_16x16x32_bf16 v[108:111], a[24:27], v[64:67], v[108:111]
  ds_read_b128 a[8:11], v10 offset:768
  v_mfma_f32_16x16x32_bf16 v[96:99], a[24:27], v[80:83], v[96:99]
  v_mfma_f32_16x16x32_bf16 v[108:111], a[28:31], v[68:71], v[108:111]
  ds_read_b128 a[12:15], v11 offset:768
  v_mfma_f32_16x16x32_bf16 v[96:99], a[28:31], v[84:87], v[96:99]
  s_waitcnt lgkmcnt(6)
  v_mfma_f32_16x16x32_bf16 v[96:99], a[32:35], v[72:75], v[96:99]
  ds_read_b128 a[16:19], v8 offset:16384
  v_mfma_f32_16x16x32_bf16 v[104:107], a[32:35], v[88:91], v[104:107]
  v_mfma_f32_16x16x32_bf16 v[96:99], a[36:39], v[76:79], v[96:99]
  ds_read_b128 a[20:23], v9 offset:16384
  v_mfma_f32_16x16x32_bf16 v[104:107], a[36:39], v[92:95], v[104:107]
  s_waitcnt lgkmcnt(6)
  v_mfma_f32_16x16x32_bf16 v[104:107], a[40:43], v[72:75], v[104:107]
  ds_read_b128 a[24:27], v8 offset:16640
  v_mfma_f32_16x16x32_bf16 v[100:103], a[40:43], v[88:91], v[100:103]
  v_mfma_f32_16x16x32_bf16 v[104:107], a[44:47], v[76:79], v[104:107]
  ds_read_b128 a[28:31], v9 offset:16640
  v_mfma_f32_16x16x32_bf16 v[100:103], a[44:47], v[92:95], v[100:103]
  s_waitcnt lgkmcnt(6)
  v_mfma_f32_16x16x32_bf16 v[100:103], a[0:3], v[72:75], v[100:103]
  ds_read_b128 a[32:35], v8 offset:16896
  v_mfma_f32_16x16x32_bf16 v[108:111], a[0:3], v[88:91], v[108:111]
  v_mfma_f32_16x16x32_bf16 v[100:103], a[4:7], v[76:79], v[100:103]
  ds_read_b128 a[36:39], v9 offset:16896
  v_mfma_f32_16x16x32_bf16 v[108:111], a[4:7], v[92:95], v[108:111]
  s_waitcnt lgkmcnt(6)
  v_mfma_f32_16x16x32_bf16 v[108:111], a[8:11], v[72:75], v[108:111]
  ds_read_b128 a[40:43], v8 offset:17152
  v_mfma_f32_16x16x32_bf16 v[96:99], a[8:11], v[88:91], v[96:99]
  ds_read_b32 v15, v0 offset:88
  v_mfma_f32_16x16x32_bf16 v[108:111], a[12:15], v[76:79], v[108:111]
  ds_read_b128 a[44:47], v9 offset:17152
  v_mfma_f32_16x16x32_bf16 v[96:99], a[12:15], v[92:95], v[96:99]
  s_waitcnt lgkmcnt(7)
  v_mfma_f32_16x16x32_bf16 v[112:115], a[16:19], v[64:67], 0
  ds_read_b128 a[0:3], v10 offset:16384
  v_mfma_f32_16x16x32_bf16 v[120:123], a[16:19], v[80:83], 0
  v_mfma_f32_16x16x32_bf16 v[112:115], a[20:23], v[68:71], v[112:115]
  ds_read_b128 a[4:7], v11 offset:16384
  v_mfma_f32_16x16x32_bf16 v[120:123], a[20:23], v[84:87], v[120:123]
  s_waitcnt lgkmcnt(7)
  v_mfma_f32_16x16x32_bf16 v[120:123], a[24:27], v[64:67], v[120:123]
  ds_read_b128 a[8:11], v10 offset:16640
  v_sub_f32 v96, v96, v100
  v_mfma_f32_16x16x32_bf16 v[116:119], a[24:27], v[80:83], 0
  s_waitcnt lgkmcnt(4)
  v_cmp_gt_u32 vcc, 1, v15
  s_cbranch_vccz L19
  s_mov_b32 s79, 0x400000
L20:
  ds_read_b32 v15, v0 offset:88
  s_waitcnt lgkmcnt(0)
  v_cmp_gt_u32 vcc, 1, v15
  s_cbranch_vccz L21
  s_sleep 1
  s_sub_u32 s79, s79, 1
  s_cbranch_scc0 L20
L21:
L19:
  ds_read_b128 a[64:67], v14 offset:0
  v_sub_f32 v97, v97, v101
  v_mfma_f32_16x16x32_bf16 v[120:123], a[28:31], v[68:71], v[120:123]
  ds_read_b128 a[12:15], v11 offset:16640
  v_sub_f32 v98, v98, v102
  v_mfma_f32_16x16x32_bf16 v[116:119], a[28:31], v[84:87], v[116:119]
  ds_read_b128 a[68:71], v14 offset:1024
  v_sub_f32 v99, v99, v103
  v_mfma_f32_16x16x32_bf16 v[116:119], a[32:35], v[64:67], v[116:119]
  ds_read_b128 a[16:19], v10 offset:16896
  v_mul_f32 v96, v96, v16
  v_mfma_f32_16x16x32_bf16 v[124:127], a[32:35], v[80:83], 0
  ds_read_b128 a[72:75], v14 offset:2048
  v_mul_f32 v97, v97, v17
  v_mfma_f32_16x16x32_bf16 v[116:119], a[36:39], v[68:71], v[116:119]
  ds_read_b128 a[20:23], v11 offset:16896
  v_mul_f32 v98, v98, v18
  v_mfma_f32_16x16x32_bf16 v[124:127], a[36:39], v[84:87], v[124:127]
  ds_read_b128 a[76:79], v14 offset:3072
  v_mul_f32 v99, v99, v19
  s_waitcnt lgkmcnt(10)
  v_mfma_f32_16x16x32_bf16 v[124:127], a[40:43], v[64:67], v[124:127]
  ds_read_b128 a[24:27], v10 offset:17152
  v_cvt_pk_bf16_f32 v24, v96, v97
  v_mfma_f32_16x16x32_bf16 v[112:115], a[40:43], v[80:83], v[112:115]
  v_cvt_pk_bf16_f32 v25, v98, v99
  v_mfma_f32_16x16x32_bf16 v[124:127], a[44:47], v[68:71], v[124:127]
  ds_read_b128 a[28:31], v11 offset:17152
  v_xor_b32 v48, s94, v24
  v_mfma_f32_16x16x32_bf16 v[112:115], a[44:47], v[84:87], v[112:115]
  v_xor_b32 v49, s94, v25
  s_waitcnt lgkmcnt(10)
  v_mfma_f32_16x16x32_bf16 v[112:115], a[0:3], v[72:75], v[112:115]
  v_sub_f32 v104, v104, v108
  v_mfma_f32_16x16x32_bf16 v[120:123], a[0:3], v[88:91], v[120:123]
  v_sub_f32 v105, v105, v109
  v_mfma_f32_16x16x32_bf16 v[112:115], a[4:7], v[76:79], v[112:115]
  v_sub_f32 v106, v106, v110
  v_mfma_f32_16x16x32_bf16 v[120:123], a[4:7], v[92:95], v[120:123]
  v_sub_f32 v107, v107, v111
  s_waitcnt lgkmcnt(7)
  v_mfma_f32_16x16x32_bf16 v[120:123], a[8:11], v[72:75], v[120:123]
  v_mul_f32 v104, v104, v16
  v_mfma_f32_16x16x32_bf16 v[116:119], a[8:11], v[88:91], v[116:119]
  v_mul_f32 v105, v105, v17
  v_mfma_f32_16x16x32_bf16 v[120:123], a[12:15], v[76:79], v[120:123]
  v_mul_f32 v106, v106, v18
  v_mfma_f32_16x16x32_bf16 v[116:119], a[12:15], v[92:95], v[116:119]
  v_mul_f32 v107, v107, v19
  s_waitcnt lgkmcnt(3)
  v_mfma_f32_16x16x32_bf16 v[116:119], a[16:19], v[72:75], v[116:119]
  v_cvt_pk_bf16_f32 v28, v104, v105
  v_mfma_f32_16x16x32_bf16 v[124:127], a[16:19], v[88:91], v[124:127]
  v_cvt_pk_bf16_f32 v29, v106, v107
  v_mfma_f32_16x16x32_bf16 v[116:119], a[20:23], v[76:79], v[116:119]
  v_xor_b32 v52, s95, v28
  v_mfma_f32_16x16x32_bf16 v[124:127], a[20:23], v[92:95], v[124:127]
  v_xor_b32 v53, s95, v29
  s_waitcnt lgkmcnt(0)
  v_mov_b32 v5, 1
  s_mov_b64 exec, 1
  ds_add_u32 v0, v5 offset:56
  s_mov_b64 exec, -1
  v_mfma_f32_16x16x32_bf16 v[124:127], a[24:27], v[72:75], v[124:127]
  v_mfma_f32_16x16x32_bf16 v[112:115], a[24:27], v[88:91], v[112:115]
  v_mfma_f32_16x16x32_bf16 v[124:127], a[28:31], v[76:79], v[124:127]
  v_mfma_f32_16x16x32_bf16 v[112:115], a[28:31], v[92:95], v[112:115]
  s_nop 7
  v_sub_f32 v112, v112, v116
  v_sub_f32 v113, v113, v117
  v_sub_f32 v114, v114, v118
  v_sub_f32 v115, v115, v119
  v_mul_f32 v112, v112, v20
  v_mul_f32 v113, v113, v21
  v_mul_f32 v114, v114, v22
  v_mul_f32 v115, v115, v23
  v_cvt_pk_bf16_f32 v26, v112, v113
  v_cvt_pk_bf16_f32 v27, v114, v115
  v_xor_b32 v50, s94, v26
  v_xor_b32 v51, s94, v27
  v_sub_f32 v120, v120, v124
  v_sub_f32 v121, v121, v125
  v_sub_f32 v122, v122, v126
  v_sub_f32 v123, v123, v127
  v_mul_f32 v120, v120, v20
  v_mul_f32 v121, v121, v21
  v_mul_f32 v122, v122, v22
  v_mul_f32 v123, v123, v23
  v_cvt_pk_bf16_f32 v30, v120, v121
  v_cvt_pk_bf16_f32 v31, v122, v123
  v_xor_b32 v54, s95, v30
  v_xor_b32 v55, s95, v31
L5:
  s_waitcnt lgkmcnt(0)
  s_nop 0
  v_mfma_f32_16x16x32_bf16 v[32:35], v[24:27], a[64:67], 0
  v_mfma_f32_16x16x32_bf16 v[36:39], v[48:51], a[68:71], 0
  v_mfma_f32_16x16x32_bf16 v[32:35], v[28:31], a[68:71], v[32:35]
  v_mfma_f32_16x16x32_bf16 v[36:39], v[52:55], a[64:67], v[36:39]
  v_mfma_f32_16x16x32_bf16 v[40:43], v[24:27], a[72:75], 0
  v_mfma_f32_16x16x32_bf16 v[44:47], v[48:51], a[76:79], 0
  v_mfma_f32_16x16x32_bf16 v[40:43], v[28:31], a[76:79], v[40:43]
  v_mfma_f32_16x16x32_bf16 v[44:47], v[52:55], a[72:75], v[44:47]
  s_add_u32 s72, s80, 0x100000
  s_nop 1
  v_cvt_pk_bf16_f32 v16, v32, v33
  v_cvt_pk_bf16_f32 v17, v34, v35
  v_cvt_pk_bf16_f32 v18, v36, v37
  v_cvt_pk_bf16_f32 v19, v38, v39
  buffer_store_dwordx4 v[16:19], v7, s[48:51], s80 offen sc1
  v_cvt_pk_bf16_f32 v20, v40, v41
  v_cvt_pk_bf16_f32 v21, v42, v43
  v_cvt_pk_bf16_f32 v22, v44, v45
  v_cvt_pk_bf16_f32 v23, v46, v47
  buffer_store_dwordx4 v[20:23], v7, s[48:51], s72 offen sc1
  v_mov_b32 v8, v56
  v_mov_b32 v119, v61
  v_lshrrev_b32 v5, 2, v1
  v_mul_u32_u24 v13, 192, v5
  v_and_b32 v5, 1, v1
  v_lshl_add_u32 v13, v5, 3, v13
  v_bfe_u32 v5, v1, 1, 1
  v_mul_u32_u24 v5, 12320, v5
  s_mul_i32 s72, s64, 48
  v_add3_u32 v13, v13, v5, s72
  v_add_u32 v14, 0x10000, v13
  v_add_u32 v15, 0x20000, v13
  s_mov_b32 s79, 0x400000
L22:
  ds_read_b32 v5, v0 offset:4
  s_waitcnt lgkmcnt(0)
  v_cmp_gt_u32 vcc, 3, v5
  s_cbranch_vccz L23
  s_sleep 1
  s_sub_u32 s79, s79, 1
  s_cbranch_scc0 L22
L23:
  ds_read_b64_tr_b16 a[0:1], v13 offset:0
  ds_read_b64_tr_b16 a[2:3], v13 offset:3072
  ds_read_b64_tr_b16 a[4:5], v13 offset:16
  ds_read_b64_tr_b16 a[6:7], v13 offset:3088
  ds_read_b64_tr_b16 a[8:9], v13 offset:32
  ds_read_b64_tr_b16 a[10:11], v13 offset:3104
  ds_read_b64_tr_b16 a[12:13], v13 offset:6144
  ds_read_b64_tr_b16 a[14:15], v13 offset:9216
  ds_read_b64_tr_b16 a[16:17], v13 offset:6160
  ds_read_b64_tr_b16 a[18:19], v13 offset:9232
  ds_read_b64_tr_b16 a[20:21], v13 offset:6176
  ds_read_b64_tr_b16 a[22:23], v13 offset:9248
  ds_read_b64_tr_b16 a[24:25], v13 offset:24608
  ds_read_b64_tr_b16 a[26:27], v13 offset:27680
  ds_read_b64_tr_b16 a[28:29], v13 offset:24624
  ds_read_b64_tr_b16 a[30:31], v13 offset:27696
  ds_read_b64_tr_b16 a[32:33], v13 offset:24640
  ds_read_b64_tr_b16 a[34:35], v13 offset:27712
  ds_read_b64_tr_b16 a[36:37], v13 offset:30752
  ds_read_b64_tr_b16 a[38:39], v13 offset:33824
  ds_read_b64_tr_b16 a[40:41], v13 offset:30768
  ds_read_b64_tr_b16 a[42:43], v13 offset:33840
  ds_read_b64_tr_b16 a[44:45], v13 offset:30784
  ds_read_b64_tr_b16 a[46:47], v13 offset:33856
  s_waitcnt lgkmcnt(0)
  v_mov_b32 v5, 1
  s_mov_b64 exec, 1
  ds_add_u32 v0, v5 offset:64
  s_mov_b64 exec, -1
  s_waitcnt vmcnt(0)
  v_mov_b32 v5, 1
  s_mov_b64 exec, 1
  ds_add_u32 v0, v5 offset:68
  s_mov_b64 exec, -1
  s_setprio 0
  buffer_load_dwordx4 v[80:83], v58, s[28:31], 0 offen
  buffer_load_dwordx3 v[84:86], v58, s[28:31], 0 offen offset:16
  buffer_load_dwordx4 v[88:91], v59, s[28:31], 0 offen
  buffer_load_dwordx4 v[92:95], v59, s[28:31], 0 offen offset:16
  s_cmp_eq_u32 s70, 0
  s_cselect_b32 s72, 0, 0x400000
  buffer_load_dword v57, v60, s[28:31], s72 offen offset:512
  v_cvt_f32_u32 v7, v8
  v_cvt_f32_u32 v6, v3
  v_mul_f32 v7, 0xbc800000, v7
  v_mul_f32 v6, 0x41000000, v6
  v_mul_f32 v6, v7, v6
  v_mov_b32 v40, v6
  v_fma_f32 v41, v7, 1.0, v6
  v_cos_f32 v42, v40
  v_cos_f32 v43, v41
  v_sin_f32 v44, v40
  v_sin_f32 v45, v41
  v_cvt_pk_bf16_f32 v64, v42, v43
  v_cvt_pk_bf16_f32 v72, v44, v45
  v_fma_f32 v40, v7, 2.0, v6
  v_fmamk_f32 v41, v7, 0x40400000, v6
  v_cos_f32 v42, v40
  v_cos_f32 v43, v41
  v_sin_f32 v44, v40
  v_sin_f32 v45, v41
  v_cvt_pk_bf16_f32 v65, v42, v43
  v_cvt_pk_bf16_f32 v73, v44, v45
  v_fma_f32 v40, v7, 4.0, v6
  v_fmamk_f32 v41, v7, 0x40a00000, v6
  v_cos_f32 v42, v40
  v_cos_f32 v43, v41
  v_sin_f32 v44, v40
  v_sin_f32 v45, v41
  v_cvt_pk_bf16_f32 v66, v42, v43
  v_cvt_pk_bf16_f32 v74, v44, v45
  v_fmamk_f32 v40, v7, 0x40c00000, v6
  v_fmamk_f32 v41, v7, 0x40e00000, v6
  v_cos_f32 v42, v40
  v_cos_f32 v43, v41
  v_sin_f32 v44, v40
  v_sin_f32 v45, v41
  v_cvt_pk_bf16_f32 v67, v42, v43
  v_cvt_pk_bf16_f32 v75, v44, v45
  v_fmamk_f32 v40, v7, 0x42000000, v6
  v_fmamk_f32 v41, v7, 0x42040000, v6
  v_cos_f32 v42, v40
  v_cos_f32 v43, v41
  v_sin_f32 v44, v40
  v_sin_f32 v45, v41
  v_cvt_pk_bf16_f32 v68, v42, v43
  v_cvt_pk_bf16_f32 v76, v44, v45
  v_fmamk_f32 v40, v7, 0x42080000, v6
  v_fmamk_f32 v41, v7, 0x420c0000, v6
  v_cos_f32 v42, v40
  v_cos_f32 v43, v41
  v_sin_f32 v44, v40
  v_sin_f32 v45, v41
  v_cvt_pk_bf16_f32 v69, v42, v43
  v_cvt_pk_bf16_f32 v77, v44, v45
  v_fmamk_f32 v40, v7, 0x42100000, v6
  v_fmamk_f32 v41, v7, 0x42140000, v6
  v_cos_f32 v42, v40
  v_cos_f32 v43, v41
  v_sin_f32 v44, v40
  v_sin_f32 v45, v41
  v_cvt_pk_bf16_f32 v70, v42, v43
  v_cvt_pk_bf16_f32 v78, v44, v45
  v_fmamk_f32 v40, v7, 0x42180000, v6
  v_fmamk_f32 v41, v7, 0x421c0000, v6
  v_cos_f32 v42, v40
  v_cos_f32 v43, v41
  v_sin_f32 v44, v40
  v_sin_f32 v45, v41
  v_cvt_pk_bf16_f32 v71, v42, v43
  v_cvt_pk_bf16_f32 v79, v44, v45
  s_lshl_b32 s72, s64, 4
  v_add_u32 v8, s72, v2
  s_lshl_b32 s72, s71, 6
  v_add_u32 v9, s72, v8
  s_xor_b32 s73, s72, 64
  s_cmp_eq_u32 s67, 0
  s_cselect_b32 s73, s72, s73
  s_cmp_eq_u32 s69, 0
  s_cselect_b32 s74, 8, 63
  s_cselect_b32 s75, 0, 99
  v_xor_b32 v10, s74, v8
  v_and_b32 v5, 55, v8
  v_cmp_eq_u32 vcc, s75, v5
  s_nop 1
  v_cndmask_b32 v10, v10, v8, vcc
  v_add_u32 v10, s73, v10
  v_lshrrev_b32 v5, 4, v9
  v_and_b32 v6, 15, v9
  v_lshlrev_b32 v5, 14, v5
  v_lshl_add_u32 v5, v6, 4, v5
  v_lshl_add_u32 v11, v3, 8, v5
  v_lshrrev_b32 v5, 4, v10
  v_and_b32 v6, 15, v10
  v_lshlrev_b32 v5, 14, v5
  v_lshl_add_u32 v5, v6, 4, v5
  v_lshl_add_u32 v12, v3, 8, v5
  v_add_u32 v12, 8192, v12
  s_lshl_b32 s72, s67, 17
  s_lshl_b32 s73, s70, 10
  s_add_u32 s81, s72, s73
  s_add_u32 s81, s81, 3145728
  v_cmp_gt_u32 vcc, 32, v1
  v_add_u32 v10, 2048, v10
  s_nop 0
  v_cndmask_b32 v118, v10, v9, vcc
  v_lshlrev_b32 v118, 2, v118
  v_and_b32 v5, 1, v3
  v_lshl_add_u32 v118, v5, 9, v118
  s_lshl_b32 s72, s67, 14
  s_add_u32 s82, s72, s73
  s_add_u32 s82, s82, 5242880
  v_bfe_u32 v5, v1, 2, 2
  v_lshl_add_u32 v5, v3, 3, v5
  v_lshlrev_b32 v7, 7, v5
  v_bfe_u32 v5, v1, 3, 1
  v_lshl_add_u32 v7, v5, 6, v7
  v_and_b32 v5, 3, v1
  v_lshl_add_u32 v7, v5, 4, v7
  v_and_b32 v5, 1, v3
  v_lshl_add_u32 v7, v5, 3, v7
  v_xor_b32 v8, 8, v7
  v_xor_b32 v9, 64, v7
  v_xor_b32 v10, 0x48, v7
  v_add_u32 v7, 147840, v7
  v_add_u32 v8, 147840, v8
  v_add_u32 v9, 147840, v9
  v_add_u32 v10, 147840, v10
  s_waitcnt vmcnt(0)
  s_mov_b32 s72, 0xffff0000
  v_lshlrev_b32 v98, 16, v80
  v_and_b32 v102, s72, v80
  v_lshlrev_b32 v99, 16, v82
  v_and_b32 v103, s72, v82
  v_lshlrev_b32 v100, 16, v84
  v_and_b32 v104, s72, v84
  v_lshlrev_b32 v101, 16, v86
  v_and_b32 v105, s72, v86
  v_cmp_eq_f32 vcc, 0, v119
  s_nop 1
  v_cndmask_b32 v95, v95, v57, vcc
  v_lshlrev_b32 v106, 16, v95
  v_and_b32 v110, s72, v94
  v_lshlrev_b32 v107, 16, v93
  v_and_b32 v111, s72, v92
  v_lshlrev_b32 v108, 16, v91
  v_and_b32 v112, s72, v90
  v_lshlrev_b32 v109, 16, v89
  v_and_b32 v113, s72, v88
  v_mov_b32 v114, 0
  v_mov_b32 v115, 0
  v_mov_b32 v116, 0
  v_mov_b32 v117, 0
  s_mov_b32 s79, 0x400000
L24:
  ds_read_b32 v5, v0 offset:16
  s_waitcnt lgkmcnt(0)
  v_cmp_gt_u32 vcc, 3, v5
  s_cbranch_vccz L25
  s_sleep 1
  s_sub_u32 s79, s79, 1
  s_cbranch_scc0 L24
L25:
  ds_read_b64_tr_b16 a[48:49], v13 offset:49216
  ds_read_b64_tr_b16 a[50:51], v13 offset:52288
  ds_read_b64_tr_b16 a[52:53], v13 offset:49232
  ds_read_b64_tr_b16 a[54:55], v13 offset:52304
  ds_read_b64_tr_b16 a[56:57], v13 offset:49248
  ds_read_b64_tr_b16 a[58:59], v13 offset:52320
  ds_read_b64_tr_b16 a[60:61], v13 offset:55360
  ds_read_b64_tr_b16 a[62:63], v13 offset:58432
  ds_read_b64_tr_b16 a[64:65], v13 offset:55376
  ds_read_b64_tr_b16 a[66:67], v13 offset:58448
  ds_read_b64_tr_b16 a[68:69], v13 offset:55392
  ds_read_b64_tr_b16 a[70:71], v13 offset:58464
  ds_read_b64_tr_b16 a[72:73], v14 offset:8288
  ds_read_b64_tr_b16 a[74:75], v14 offset:11360
  ds_read_b64_tr_b16 a[76:77], v14 offset:8304
  ds_read_b64_tr_b16 a[78:79], v14 offset:11376
  ds_read_b64_tr_b16 a[80:81], v14 offset:8320
  ds_read_b64_tr_b16 a[82:83], v14 offset:11392
  ds_read_b64_tr_b16 a[84:85], v14 offset:14432
  ds_read_b64_tr_b16 a[86:87], v14 offset:17504
  ds_read_b64_tr_b16 a[88:89], v14 offset:14448
  ds_read_b64_tr_b16 a[90:91], v14 offset:17520
  ds_read_b64_tr_b16 a[92:93], v14 offset:14464
  ds_read_b64_tr_b16 a[94:95], v14 offset:17536
  ds_read_b64_tr_b16 a[96:97], v14 offset:32896
  ds_read_b64_tr_b16 a[98:99], v14 offset:35968
  ds_read_b64_tr_b16 a[100:101], v14 offset:32912
  ds_read_b64_tr_b16 a[102:103], v14 offset:35984
  ds_read_b64_tr_b16 a[104:105], v14 offset:32928
  ds_read_b64_tr_b16 a[106:107], v14 offset:36000
  ds_read_b64_tr_b16 a[108:109], v14 offset:39040
  ds_read_b64_tr_b16 a[110:111], v14 offset:42112
  ds_read_b64_tr_b16 a[112:113], v14 offset:39056
  ds_read_b64_tr_b16 a[114:115], v14 offset:42128
  ds_read_b64_tr_b16 a[116:117], v14 offset:39072
  ds_read_b64_tr_b16 a[118:119], v14 offset:42144
  s_setprio 1
  s_mov_b32 s79, 0x400000
L26:
  ds_read_b32 v5, v0 offset:76
  s_waitcnt lgkmcnt(0)
  v_cmp_gt_u32 vcc, 1, v5
  s_cbranch_vccz L27
  s_sleep 1
  s_sub_u32 s79, s79, 1
  s_cbranch_scc0 L26
L27:
  ds_read_b64_tr_b16 v[16:17], v7 offset:0
  ds_read_b64_tr_b16 v[18:19], v7 offset:512
  ds_read_b64_tr_b16 v[20:21], v9 offset:0
  ds_read_b64_tr_b16 v[22:23], v9 offset:512
  ds_read_b64_tr_b16 v[24:25], v7 offset:4096
  ds_read_b64_tr_b16 v[26:27], v7 offset:4608
  ds_read_b64_tr_b16 v[28:29], v9 offset:4096
  ds_read_b64_tr_b16 v[30:31], v9 offset:4608
  ds_read_b64_tr_b16 v[32:33], v8 offset:0
  ds_read_b64_tr_b16 v[34:35], v8 offset:512
  ds_read_b64_tr_b16 v[36:37], v10 offset:0
  ds_read_b64_tr_b16 v[38:39], v10 offset:512
  ds_read_b64_tr_b16 v[40:41], v8 offset:4096
  ds_read_b64_tr_b16 v[42:43], v8 offset:4608
  ds_read_b64_tr_b16 v[44:45], v10 offset:4096
  ds_read_b64_tr_b16 v[46:47], v10 offset:4608
  s_waitcnt lgkmcnt(14)
  v_mfma_f32_16x16x32_bf16 v[48:51], v[16:19], v[64:67], 0
  s_waitcnt lgkmcnt(12)
  v_mfma_f32_16x16x32_bf16 v[52:55], v[20:23], v[64:67], 0
  s_waitcnt lgkmcnt(10)
  v_mfma_f32_16x16x32_bf16 v[48:51], v[24:27], v[68:71], v[48:51]
  s_waitcnt lgkmcnt(8)
  v_mfma_f32_16x16x32_bf16 v[52:55], v[28:31], v[68:71], v[52:55]
  s_waitcnt lgkmcnt(6)
  v_mfma_f32_16x16x32_bf16 v[48:51], v[32:35], v[72:75], v[48:51]
  s_waitcnt lgkmcnt(4)
  v_mfma_f32_16x16x32_bf16 v[52:55], v[36:39], v[72:75], v[52:55]
  s_waitcnt lgkmcnt(2)
  v_mfma_f32_16x16x32_bf16 v[48:51], v[40:43], v[76:79], v[48:51]
  s_waitcnt lgkmcnt(0)
  v_mfma_f32_16x16x32_bf16 v[52:55], v[44:47], v[76:79], v[52:55]
  s_nop 5
  v_fmac_f32 v98, v48, v119
  v_add_f32 v99, v99, v49
  v_add_f32 v100, v100, v50
  v_add_f32 v101, v101, v51
  v_add_f32 v102, v102, v52
  v_add_f32 v103, v103, v53
  v_add_f32 v104, v104, v54
  v_add_f32 v105, v105, v55
  v_cvt_pk_bf16_f32 v56, v98, v99
  v_cvt_pk_bf16_f32 v57, v100, v101
  v_cvt_pk_bf16_f32 v58, v102, v103
  v_cvt_pk_bf16_f32 v59, v104, v105
  buffer_store_dwordx4 v[56:59], v11, s[48:51], s81 offen sc1
  v_add_f32 v106, v106, v48
  v_add_f32 v107, v107, v49
  v_add_f32 v108, v108, v50
  v_add_f32 v109, v109, v51
  v_add_f32 v110, v110, v52
  v_add_f32 v111, v111, v53
  v_add_f32 v112, v112, v54
  v_add_f32 v113, v113, v55
  v_cvt_pk_bf16_f32 v60, v106, v107
  v_cvt_pk_bf16_f32 v61, v108, v109
  v_cvt_pk_bf16_f32 v62, v110, v111
  v_cvt_pk_bf16_f32 v63, v112, v113
  buffer_store_dwordx4 v[60:63], v12, s[48:51], s81 offen sc1
  v_dot2c_f32_bf16 v114, s3, v56
  v_dot2c_f32_bf16 v115, v56, v56
  v_dot2c_f32_bf16 v116, s3, v60
  v_dot2c_f32_bf16 v117, v60, v60
  v_dot2c_f32_bf16 v114, s3, v57
  v_dot2c_f32_bf16 v115, v57, v57
  v_dot2c_f32_bf16 v116, s3, v61
  v_dot2c_f32_bf16 v117, v61, v61
  v_dot2c_f32_bf16 v114, s3, v58
  v_dot2c_f32_bf16 v115, v58, v58
  v_dot2c_f32_bf16 v116, s3, v62
  v_dot2c_f32_bf16 v117, v62, v62
  v_dot2c_f32_bf16 v114, s3, v59
  v_dot2c_f32_bf16 v115, v59, v59
  v_dot2c_f32_bf16 v116, s3, v63
  v_dot2c_f32_bf16 v117, v63, v63
  s_nop 1
  v_permlane32_swap_b32 v114, v116
  v_permlane32_swap_b32 v115, v117
  v_add_f32 v114, v114, v116
  v_add_f32 v115, v115, v117
  s_nop 1
  v_permlane16_swap_b32 v114, v115
  v_add_f32 v114, v114, v115
  buffer_store_dword v114, v118, s[48:51], s82 offen sc1
  v_mov_b32 v5, 1
  s_mov_b64 exec, 1
  ds_add_u32 v0, v5 offset:124
  s_mov_b64 exec, -1
  v_mov_b32 v44, s3
  v_mov_b32 v45, s3
  v_mov_b32 v46, s3
  v_mov_b32 v47, s3
  s_nop 1
  v_mfma_f32_16x16x32_bf16 v[28:31], a[0:3], v[44:47], 0
  v_mfma_f32_16x16x32_bf16 v[32:35], a[4:7], v[44:47], 0
  v_mfma_f32_16x16x32_bf16 v[36:39], a[8:11], v[44:47], 0
  v_mfma_f32_16x16x32_bf16 v[28:31], a[12:15], v[44:47], v[28:31]
  v_mfma_f32_16x16x32_bf16 v[32:35], a[16:19], v[44:47], v[32:35]
  v_mfma_f32_16x16x32_bf16 v[36:39], a[20:23], v[44:47], v[36:39]
  v_mfma_f32_16x16x32_bf16 v[28:31], a[24:27], v[44:47], v[28:31]
  v_mfma_f32_16x16x32_bf16 v[32:35], a[28:31], v[44:47], v[32:35]
  v_mfma_f32_16x16x32_bf16 v[36:39], a[32:35], v[44:47], v[36:39]
  v_mfma_f32_16x16x32_bf16 v[28:31], a[36:39], v[44:47], v[28:31]
  v_mfma_f32_16x16x32_bf16 v[32:35], a[40:43], v[44:47], v[32:35]
  v_mfma_f32_16x16x32_bf16 v[36:39], a[44:47], v[44:47], v[36:39]
  v_mfma_f32_16x16x32_bf16 v[28:31], a[48:51], v[44:47], v[28:31]
  v_mfma_f32_16x16x32_bf16 v[32:35], a[52:55], v[44:47], v[32:35]
  v_mfma_f32_16x16x32_bf16 v[36:39], a[56:59], v[44:47], v[36:39]
  v_mfma_f32_16x16x32_bf16 v[28:31], a[60:63], v[44:47], v[28:31]
  v_mfma_f32_16x16x32_bf16 v[32:35], a[64:67], v[44:47], v[32:35]
  v_mfma_f32_16x16x32_bf16 v[36:39], a[68:71], v[44:47], v[36:39]
  v_mfma_f32_16x16x32_bf16 v[28:31], a[72:75], v[44:47], v[28:31]
  v_mfma_f32_16x16x32_bf16 v[32:35], a[76:79], v[44:47], v[32:35]
  v_mfma_f32_16x16x32_bf16 v[36:39], a[80:83], v[44:47], v[36:39]
  v_mfma_f32_16x16x32_bf16 v[28:31], a[84:87], v[44:47], v[28:31]
  v_mfma_f32_16x16x32_bf16 v[32:35], a[88:91], v[44:47], v[32:35]
  v_mfma_f32_16x16x32_bf16 v[36:39], a[92:95], v[44:47], v[36:39]
  s_waitcnt vmcnt(0)
  v_mov_b32 v5, 1
  s_mov_b64 exec, 1
  ds_add_u32 v0, v5 offset:72
  s_mov_b64 exec, -1
  s_lshl_b32 s73, s64, 12
  s_add_u32 s88, s73, 24576
  s_lshl_b32 s72, s68, 17
  s_add_u32 s89, s72, s73
  s_add_u32 s89, s89, 3145728
  s_mov_b32 s79, 0x400000
L28:
  ds_read_b32 v5, v0 offset:28
  s_waitcnt lgkmcnt(0)
  v_cmp_gt_u32 vcc, 3, v5
  s_cbranch_vccz L29
  s_sleep 1
  s_sub_u32 s79, s79, 1
  s_cbranch_scc0 L28
L29:
  ds_read_b64_tr_b16 a[120:121], v14 offset:57600
  ds_read_b64_tr_b16 a[122:123], v14 offset:60672
  ds_read_b64_tr_b16 a[124:125], v14 offset:57616
  ds_read_b64_tr_b16 a[126:127], v14 offset:60688
  ds_read_b64_tr_b16 v[64:65], v14 offset:57632
  ds_read_b64_tr_b16 v[66:67], v14 offset:60704
  ds_read_b64_tr_b16 v[68:69], v14 offset:63744
  ds_read_b64_tr_b16 v[70:71], v15 offset:1280
  ds_read_b64_tr_b16 v[72:73], v14 offset:63760
  ds_read_b64_tr_b16 v[74:75], v15 offset:1296
  ds_read_b64_tr_b16 v[76:77], v14 offset:63776
  ds_read_b64_tr_b16 v[78:79], v15 offset:1312
  ds_read_b64_tr_b16 v[80:81], v13 offset:0
  ds_read_b64_tr_b16 v[82:83], v13 offset:3072
  ds_read_b64_tr_b16 v[84:85], v13 offset:16
  ds_read_b64_tr_b16 v[86:87], v13 offset:3088
  ds_read_b64_tr_b16 v[88:89], v13 offset:32
  ds_read_b64_tr_b16 v[90:91], v13 offset:3104
  ds_read_b64_tr_b16 v[92:93], v13 offset:6144
  ds_read_b64_tr_b16 v[94:95], v13 offset:9216
  ds_read_b64_tr_b16 v[96:97], v13 offset:6160
  ds_read_b64_tr_b16 v[98:99], v13 offset:9232
  ds_read_b64_tr_b16 v[100:101], v13 offset:6176
  ds_read_b64_tr_b16 v[102:103], v13 offset:9248
  ds_read_b64_tr_b16 v[104:105], v13 offset:24608
  ds_read_b64_tr_b16 v[106:107], v13 offset:27680
  ds_read_b64_tr_b16 v[108:109], v13 offset:24624
  ds_read_b64_tr_b16 v[110:111], v13 offset:27696
  ds_read_b64_tr_b16 v[112:113], v13 offset:24640
  ds_read_b64_tr_b16 v[114:115], v13 offset:27712
  ds_read_b64_tr_b16 v[116:117], v13 offset:30752
  ds_read_b64_tr_b16 v[118:119], v13 offset:33824
  ds_read_b64_tr_b16 v[120:121], v13 offset:30768
  ds_read_b64_tr_b16 v[122:123], v13 offset:33840
  ds_read_b64_tr_b16 v[124:125], v13 offset:30784
  ds_read_b64_tr_b16 v[126:127], v13 offset:33856
  v_add_u32 v7, 24576, v4
  v_add_u32 v8, 90112, v4
  v_mfma_f32_16x16x32_bf16 v[28:31], a[96:99], v[44:47], v[28:31]
  v_mfma_f32_16x16x32_bf16 v[32:35], a[100:103], v[44:47], v[32:35]
  v_mfma_f32_16x16x32_bf16 v[36:39], a[104:107], v[44:47], v[36:39]
  v_mfma_f32_16x16x32_bf16 v[28:31], a[108:111], v[44:47], v[28:31]
  v_mfma_f32_16x16x32_bf16 v[32:35], a[112:115], v[44:47], v[32:35]
  v_mfma_f32_16x16x32_bf16 v[36:39], a[116:119], v[44:47], v[36:39]
  s_waitcnt lgkmcnt(0)
  v_mov_b32 v5, 1
  s_mov_b64 exec, 1
  ds_add_u32 v0, v5 offset:84
  s_mov_b64 exec, -1
  s_mov_b32 s79, 0x400000
L30:
  ds_read_b32 v5, v0 offset:124
  s_waitcnt lgkmcnt(0)
  v_cmp_gt_u32 vcc, 5, v5
  s_cbranch_vccz L31
  s_sleep 1
  s_sub_u32 s79, s79, 1
  s_cbranch_scc0 L30
L31:
  s_mov_b32 s79, 0x400000
L32:
  ds_read_b32 v5, v0 offset:84
  s_waitcnt lgkmcnt(0)
  v_cmp_gt_u32 vcc, 4, v5
  s_cbranch_vccz L33
  s_sleep 1
  s_sub_u32 s79, s79, 1
  s_cbranch_scc0 L32
L33:
  s_add_u32 m0, s88, 32768
  s_add_u32 s72, s89, 0
  buffer_load_dwordx4 v4, s[48:51], s72 offen offset:0 sc1 lds
  buffer_load_dwordx4 v4, s[48:51], s72 offen offset:1024 sc1 lds
  buffer_load_dwordx4 v4, s[48:51], s72 offen offset:2048 sc1 lds
  buffer_load_dwordx4 v4, s[48:51], s72 offen offset:3072 sc1 lds
  s_add_u32 m0, s88, 49152
  s_add_u32 s72, s89, 16384
  buffer_load_dwordx4 v4, s[48:51], s72 offen offset:0 sc1 lds
  buffer_load_dwordx4 v4, s[48:51], s72 offen offset:1024 sc1 lds
  buffer_load_dwordx4 v4, s[48:51], s72 offen offset:2048 sc1 lds
  buffer_load_dwordx4 v4, s[48:51], s72 offen offset:3072 sc1 lds
  v_mfma_f32_16x16x32_bf16 v[28:31], a[120:123], v[44:47], v[28:31]
  v_mfma_f32_16x16x32_bf16 v[32:35], a[124:127], v[44:47], v[32:35]
  v_mfma_f32_16x16x32_bf16 v[36:39], v[64:67], v[44:47], v[36:39]
  v_mfma_f32_16x16x32_bf16 v[28:31], v[68:71], v[44:47], v[28:31]
  v_mfma_f32_16x16x32_bf16 v[32:35], v[72:75], v[44:47], v[32:35]
  v_mfma_f32_16x16x32_bf16 v[36:39], v[76:79], v[44:47], v[36:39]
  v_mfma_f32_16x16x32_bf16 v[28:31], v[80:83], v[44:47], v[28:31]
  v_mfma_f32_16x16x32_bf16 v[32:35], v[84:87], v[44:47], v[32:35]
  v_mfma_f32_16x16x32_bf16 v[36:39], v[88:91], v[44:47], v[36:39]
  v_mfma_f32_16x16x32_bf16 v[28:31], v[92:95], v[44:47], v[28:31]
  v_mfma_f32_16x16x32_bf16 v[32:35], v[96:99], v[44:47], v[32:35]
  v_mfma_f32_16x16x32_bf16 v[36:39], v[100:103], v[44:47], v[36:39]
  v_mfma_f32_16x16x32_bf16 v[28:31], v[104:107], v[44:47], v[28:31]
  v_mfma_f32_16x16x32_bf16 v[32:35], v[108:111], v[44:47], v[32:35]
  v_mfma_f32_16x16x32_bf16 v[36:39], v[112:115], v[44:47], v[36:39]
  v_mfma_f32_16x16x32_bf16 v[28:31], v[116:119], v[44:47], v[28:31]
  v_mfma_f32_16x16x32_bf16 v[32:35], v[120:123], v[44:47], v[32:35]
  v_mfma_f32_16x16x32_bf16 v[36:39], v[124:127], v[44:47], v[36:39]
  v_mov_b32 v9, 0
  s_lshl_b32 s84, s67, 7
  s_add_u32 s84, s84, 14336
  v_and_b32 v5, 31, v1
  v_lshlrev_b32 v12, 2, v5
  v_and_b32 v6, 32, v1
  v_lshl_add_u32 v12, v6, 4, v12
  s_mul_i32 s73, s64, 3072
  v_add_u32 v12, s73, v12
  v_add_u32 v13, 128, v12
  s_mul_i32 s73, s64, 192
  s_add_u32 s73, s73, 157440
  v_mul_u32_u24 v14, 48, v3
  v_add_u32 v14, s73, v14
  v_lshlrev_b32 v15, 3, v2
  v_add_u32 v15, 157312, v15
  v_and_b32 v5, 1, v3
  v_lshlrev_b32 v10, 3, v5
  v_lshl_add_u32 v10, v2, 4, v10
  v_lshrrev_b32 v6, 3, v6
  v_add_u32 v10, v10, v6
  s_mul_i32 s73, s68, 393216
  s_lshl_b32 s74, s90, 2
  s_add_u32 s74, s74, s64
  s_mul_i32 s74, s74, 768
  s_add_u32 s82, s73, s74
  s_add_u32 s82, s82, 7684096
  s_mov_b32 s79, 0x400000
L34:
  ds_read_b32 v5, v0 offset:84
  s_waitcnt lgkmcnt(0)
  v_cmp_gt_u32 vcc, 4, v5
  s_cbranch_vccz L35
  s_sleep 1
  s_sub_u32 s79, s79, 1
  s_cbranch_scc0 L34
L35:
  s_mul_i32 s83, s64, 3072
  s_mov_b32 m0, s83
  s_nop 0
  ds_write_addtid_b32 v28 offset:12288
  ds_write_addtid_b32 v29 offset:12544
  ds_write_addtid_b32 v30 offset:12800
  ds_write_addtid_b32 v31 offset:13056
  ds_write_addtid_b32 v32 offset:13312
  ds_write_addtid_b32 v33 offset:13568
  ds_write_addtid_b32 v34 offset:13824
  ds_write_addtid_b32 v35 offset:14080
  ds_write_addtid_b32 v36 offset:14336
  ds_write_addtid_b32 v37 offset:14592
  ds_write_addtid_b32 v38 offset:14848
  ds_write_addtid_b32 v39 offset:15104
  v_add_u32 v6, s88, v4
  s_mov_b32 s78, 131072
L36:
  s_waitcnt vmcnt(4)
  ds_read_b128 v[16:19], v6 offset:32768
  ds_read_b128 v[20:23], v6 offset:33792
  ds_read_b128 v[40:43], v6 offset:34816
  ds_read_b128 v[44:47], v6 offset:35840
  s_waitcnt vmcnt(0)
  ds_read_b128 v[48:51], v6 offset:49152
  ds_read_b128 v[52:55], v6 offset:50176
  ds_read_b128 v[56:59], v6 offset:51200
  ds_read_b128 v[60:63], v6 offset:52224
  s_waitcnt lgkmcnt(7)
  v_max3_u32 v24, v16, v17, v16
  v_max3_u32 v24, v18, v19, v24
  s_waitcnt lgkmcnt(6)
  v_max3_u32 v24, v20, v21, v24
  v_max3_u32 v24, v22, v23, v24
  s_waitcnt lgkmcnt(5)
  v_max3_u32 v24, v40, v41, v24
  v_max3_u32 v24, v42, v43, v24
  s_waitcnt lgkmcnt(4)
  v_max3_u32 v24, v44, v45, v24
  v_max3_u32 v24, v46, v47, v24
  s_waitcnt lgkmcnt(3)
  v_max3_u32 v24, v48, v49, v24
  v_max3_u32 v24, v50, v51, v24
  s_waitcnt lgkmcnt(2)
  v_max3_u32 v24, v52, v53, v24
  v_max3_u32 v24, v54, v55, v24
  s_waitcnt lgkmcnt(1)
  v_max3_u32 v24, v56, v57, v24
  v_max3_u32 v24, v58, v59, v24
  s_waitcnt lgkmcnt(0)
  v_max3_u32 v24, v60, v61, v24
  v_max3_u32 v24, v62, v63, v24
  v_cmp_eq_u32 vcc, -1, v24
  s_cbranch_vccz L36d
  s_add_u32 m0, s88, 32768
  s_add_u32 s72, s89, 0
  buffer_load_dwordx4 v4, s[48:51], s72 offen offset:0 sc1 lds
  buffer_load_dwordx4 v4, s[48:51], s72 offen offset:1024 sc1 lds
  buffer_load_dwordx4 v4, s[48:51], s72 offen offset:2048 sc1 lds
  buffer_load_dwordx4 v4, s[48:51], s72 offen offset:3072 sc1 lds
  s_add_u32 m0, s88, 49152
  s_add_u32 s72, s89, 16384
  buffer_load_dwordx4 v4, s[48:51], s72 offen offset:0 sc1 lds
  buffer_load_dwordx4 v4, s[48:51], s72 offen offset:1024 sc1 lds
  buffer_load_dwordx4 v4, s[48:51], s72 offen offset:2048 sc1 lds
  buffer_load_dwordx4 v4, s[48:51], s72 offen offset:3072 sc1 lds
  s_sub_u32 s78, s78, 1
  s_cbranch_scc0 L36
  s_waitcnt vmcnt(0)
L36d:
  s_mov_b32 m0, s83
  v_mov_b32 v5, 1
  s_mov_b64 exec, 1
  ds_add_u32 v0, v5 offset:60
  s_mov_b64 exec, -1
  s_mov_b32 s79, 0x400000
L37:
  ds_read_b32 v5, v0 offset:60
  s_waitcnt lgkmcnt(0)
  v_cmp_gt_u32 vcc, 4, v5
  s_cbranch_vccz L38
  s_sleep 1
  s_sub_u32 s79, s79, 1
  s_cbranch_scc0 L37
L38:
  ds_read_b128 v[40:43], v7 offset:32768
  ds_read_b128 v[44:47], v7 offset:33792
  ds_read_b128 v[48:51], v7 offset:34816
  ds_read_b128 v[52:55], v7 offset:35840
  ds_read_b128 v[56:59], v7 offset:36864
  s_waitcnt lgkmcnt(4)
  v_mfma_f32_16x16x32_bf16 v[16:19], a[0:3], v[40:43], 0
  ds_read_b128 v[60:63], v7 offset:37888
  v_mfma_f32_16x16x32_bf16 v[20:23], a[4:7], v[40:43], 0
  v_mfma_f32_16x16x32_bf16 v[24:27], a[8:11], v[40:43], 0
  s_waitcnt lgkmcnt(4)
  v_mfma_f32_16x16x32_bf16 v[16:19], a[12:15], v[44:47], v[16:19]
  ds_read_b128 v[40:43], v7 offset:38912
  v_mfma_f32_16x16x32_bf16 v[20:23], a[16:19], v[44:47], v[20:23]
  v_mfma_f32_16x16x32_bf16 v[24:27], a[20:23], v[44:47], v[24:27]
  s_waitcnt lgkmcnt(4)
  v_mfma_f32_16x16x32_bf16 v[16:19], a[24:27], v[48:51], v[16:19]
  ds_read_b128 v[44:47], v7 offset:39936
  v_mfma_f32_16x16x32_bf16 v[20:23], a[28:31], v[48:51], v[20:23]
  v_mfma_f32_16x16x32_bf16 v[24:27], a[32:35], v[48:51], v[24:27]
  s_waitcnt lgkmcnt(4)
  v_mfma_f32_16x16x32_bf16 v[16:19], a[36:39], v[52:55], v[16:19]
  ds_read_b128 v[48:51], v7 offset:40960
  v_mfma_f32_16x16x32_bf16 v[20:23], a[40:43], v[52:55], v[20:23]
  v_mfma_f32_16x16x32_bf16 v[24:27], a[44:47], v[52:55], v[24:27]
  s_waitcnt lgkmcnt(4)
  v_mfma_f32_16x16x32_bf16 v[16:19], a[48:51], v[56:59], v[16:19]
  ds_read_b128 v[52:55], v7 offset:41984
  v_mfma_f32_16x16x32_bf16 v[20:23], a[52:55], v[56:59], v[20:23]
  v_mfma_f32_16x16x32_bf16 v[24:27], a[56:59], v[56:59], v[24:27]
  s_waitcnt lgkmcnt(4)
  v_mfma_f32_16x16x32_bf16 v[16:19], a[60:63], v[60:63], v[16:19]
  ds_read_b128 v[56:59], v7 offset:43008
  v_mfma_f32_16x16x32_bf16 v[20:23], a[64:67], v[60:63], v[20:23]
  v_mfma_f32_16x16x32_bf16 v[24:27], a[68:71], v[60:63], v[24:27]
  s_waitcnt lgkmcnt(4)
  v_mfma_f32_16x16x32_bf16 v[16:19], a[72:75], v[40:43], v[16:19]
  ds_read_b128 v[60:63], v7 offset:44032
  v_mfma_f32_16x16x32_bf16 v[20:23], a[76:79], v[40:43], v[20:23]
  v_mfma_f32_16x16x32_bf16 v[24:27], a[80:83], v[40:43], v[24:27]
  s_waitcnt lgkmcnt(4)
  v_mfma_f32_16x16x32_bf16 v[16:19], a[84:87], v[44:47], v[16:19]
  ds_read_b128 v[40:43], v7 offset:45056
  v_mfma_f32_16x16x32_bf16 v[20:23], a[88:91], v[44:47], v[20:23]
  v_mfma_f32_16x16x32_bf16 v[24:27], a[92:95], v[44:47], v[24:27]
  s_waitcnt lgkmcnt(4)
  v_mfma_f32_16x16x32_bf16 v[16:19], a[96:99], v[48:51], v[16:19]
  ds_read_b128 v[44:47], v7 offset:46080
  v_mfma_f32_16x16x32_bf16 v[20:23], a[100:103], v[48:51], v[20:23]
  v_mfma_f32_16x16x32_bf16 v[24:27], a[104:107], v[48:51], v[24:27]
  s_waitcnt lgkmcnt(4)
  v_mfma_f32_16x16x32_bf16 v[16:19], a[108:111], v[52:55], v[16:19]
  ds_read_b128 v[48:51], v7 offset:47104
  v_mfma_f32_16x16x32_bf16 v[20:23], a[112:115], v[52:55], v[20:23]
  v_mfma_f32_16x16x32_bf16 v[24:27], a[116:119], v[52:55], v[24:27]
  s_waitcnt lgkmcnt(4)
  v_mfma_f32_16x16x32_bf16 v[16:19], a[120:123], v[56:59], v[16:19]
  ds_read_b128 v[52:55], v7 offset:48128
  v_mfma_f32_16x16x32_bf16 v[20:23], a[124:127], v[56:59], v[20:23]
  v_mfma_f32_16x16x32_bf16 v[24:27], v[64:67], v[56:59], v[24:27]
  s_waitcnt lgkmcnt(4)
  v_mfma_f32_16x16x32_bf16 v[16:19], v[68:71], v[60:63], v[16:19]
  ds_read_b128 v[56:59], v7 offset:49152
  v_mfma_f32_16x16x32_bf16 v[20:23], v[72:75], v[60:63], v[20:23]
  v_mfma_f32_16x16x32_bf16 v[24:27], v[76:79], v[60:63], v[24:27]
  s_waitcnt lgkmcnt(4)
  v_mfma_f32_16x16x32_bf16 v[16:19], v[80:83], v[40:43], v[16:19]
  ds_read_b128 v[60:63], v7 offset:50176
  v_mfma_f32_16x16x32_bf16 v[20:23], v[84:87], v[40:43], v[20:23]
  v_mfma_f32_16x16x32_bf16 v[24:27], v[88:91], v[40:43], v[24:27]
  s_waitcnt lgkmcnt(4)
  v_mfma_f32_16x16x32_bf16 v[16:19], v[92:95], v[44:47], v[16:19]
  ds_read_b128 v[40:43], v7 offset:51200
  v_mfma_f32_16x16x32_bf16 v[20:23], v[96:99], v[44:47], v[20:23]
  v_mfma_f32_16x16x32_bf16 v[24:27], v[100:103], v[44:47], v[24:27]
  s_waitcnt lgkmcnt(4)
  v_mfma_f32_16x16x32_bf16 v[16:19], v[104:107], v[48:51], v[16:19]
  ds_read_b128 v[44:47], v7 offset:52224
  v_mfma_f32_16x16x32_bf16 v[20:23], v[108:111], v[48:51], v[20:23]
  v_mfma_f32_16x16x32_bf16 v[24:27], v[112:115], v[48:51], v[24:27]
  s_waitcnt lgkmcnt(4)
  v_mfma_f32_16x16x32_bf16 v[16:19], v[116:119], v[52:55], v[16:19]
  ds_read_b128 v[48:51], v7 offset:53248
  v_mfma_f32_16x16x32_bf16 v[20:23], v[120:123], v[52:55], v[20:23]
  v_mfma_f32_16x16x32_bf16 v[24:27], v[124:127], v[52:55], v[24:27]
  s_waitcnt lgkmcnt(4)
  v_mfma_f32_16x16x32_bf16 v[28:31], a[0:3], v[56:59], 0
  ds_read_b128 v[52:55], v7 offset:54272
  v_mfma_f32_16x16x32_bf16 v[32:35], a[4:7], v[56:59], 0
  v_mfma_f32_16x16x32_bf16 v[36:39], a[8:11], v[56:59], 0
  s_waitcnt lgkmcnt(4)
  v_mfma_f32_16x16x32_bf16 v[28:31], a[12:15], v[60:63], v[28:31]
  ds_read_b128 v[56:59], v7 offset:55296
  v_mfma_f32_16x16x32_bf16 v[32:35], a[16:19], v[60:63], v[32:35]
  v_mfma_f32_16x16x32_bf16 v[36:39], a[20:23], v[60:63], v[36:39]
  s_waitcnt lgkmcnt(4)
  v_mfma_f32_16x16x32_bf16 v[28:31], a[24:27], v[40:43], v[28:31]
  ds_read_b128 v[60:63], v7 offset:56320
  v_mfma_f32_16x16x32_bf16 v[32:35], a[28:31], v[40:43], v[32:35]
  ds_write_addtid_b32 v16 offset:0
  v_mfma_f32_16x16x32_bf16 v[36:39], a[32:35], v[40:43], v[36:39]
  ds_write_addtid_b32 v17 offset:256
  s_waitcnt lgkmcnt(6)
  v_mfma_f32_16x16x32_bf16 v[28:31], a[36:39], v[44:47], v[28:31]
  ds_read_b128 v[40:43], v7 offset:57344
  v_mfma_f32_16x16x32_bf16 v[32:35], a[40:43], v[44:47], v[32:35]
  ds_write_addtid_b32 v18 offset:512
  v_mfma_f32_16x16x32_bf16 v[36:39], a[44:47], v[44:47], v[36:39]
  ds_write_addtid_b32 v19 offset:768
  s_waitcnt lgkmcnt(8)
  v_mfma_f32_16x16x32_bf16 v[28:31], a[48:51], v[48:51], v[28:31]
  ds_read_b128 v[44:47], v7 offset:58368
  v_mfma_f32_16x16x32_bf16 v[32:35], a[52:55], v[48:51], v[32:35]
  ds_write_addtid_b32 v20 offset:1024
  v_mfma_f32_16x16x32_bf16 v[36:39], a[56:59], v[48:51], v[36:39]
  ds_write_addtid_b32 v21 offset:1280
  s_waitcnt lgkmcnt(10)
  v_mfma_f32_16x16x32_bf16 v[28:31], a[60:63], v[52:55], v[28:31]
  ds_read_b128 v[48:51], v7 offset:59392
  v_mfma_f32_16x16x32_bf16 v[32:35], a[64:67], v[52:55], v[32:35]
  ds_write_addtid_b32 v22 offset:1536
  v_mfma_f32_16x16x32_bf16 v[36:39], a[68:71], v[52:55], v[36:39]
  ds_write_addtid_b32 v23 offset:1792
  s_waitcnt lgkmcnt(12)
  v_mfma_f32_16x16x32_bf16 v[28:31], a[72:75], v[56:59], v[28:31]
  ds_read_b128 v[52:55], v7 offset:60416
  v_mfma_f32_16x16x32_bf16 v[32:35], a[76:79], v[56:59], v[32:35]
  ds_write_addtid_b32 v24 offset:2048
  v_mfma_f32_16x16x32_bf16 v[36:39], a[80:83], v[56:59], v[36:39]
  ds_write_addtid_b32 v25 offset:2304
  s_waitcnt lgkmcnt(14)
  v_mfma_f32_16x16x32_bf16 v[28:31], a[84:87], v[60:63], v[28:31]
  ds_read_b128 v[56:59], v7 offset:61440
  v_mfma_f32_16x16x32_bf16 v[32:35], a[88:91], v[60:63], v[32:35]
  ds_write_addtid_b32 v26 offset:2560
  v_mfma_f32_16x16x32_bf16 v[36:39], a[92:95], v[60:63], v[36:39]
  ds_write_addtid_b32 v27 offset:2816
  s_waitcnt lgkmcnt(14)
  v_mfma_f32_16x16x32_bf16 v[28:31], a[96:99], v[40:43], v[28:31]
  ds_read_b128 v[60:63], v7 offset:62464
  v_mfma_f32_16x16x32_bf16 v[32:35], a[100:103], v[40:43], v[32:35]
  v_mfma_f32_16x16x32_bf16 v[36:39], a[104:107], v[40:43], v[36:39]
  s_waitcnt lgkmcnt(12)
  v_mfma_f32_16x16x32_bf16 v[28:31], a[108:111], v[44:47], v[28:31]
  ds_read_b128 v[40:43], v7 offset:63488
  v_mfma_f32_16x16x32_bf16 v[32:35], a[112:115], v[44:47], v[32:35]
  v_mfma_f32_16x16x32_bf16 v[36:39], a[116:119], v[44:47], v[36:39]
  s_waitcnt lgkmcnt(2)
  s_barrier
  v_mfma_f32_16x16x32_bf16 v[28:31], a[120:123], v[48:51], v[28:31]
  ds_read_b128 v[44:47], v7 offset:64512
  v_mfma_f32_16x16x32_bf16 v[32:35], a[124:127], v[48:51], v[32:35]
  v_mfma_f32_16x16x32_bf16 v[36:39], v[64:67], v[48:51], v[36:39]
  v_mfma_f32_16x16x32_bf16 v[28:31], v[68:71], v[52:55], v[28:31]
  ds_read_b128 v[48:51], v8 offset:0
  v_mfma_f32_16x16x32_bf16 v[32:35], v[72:75], v[52:55], v[32:35]
  v_mfma_f32_16x16x32_bf16 v[36:39], v[76:79], v[52:55], v[36:39]
  v_mfma_f32_16x16x32_bf16 v[28:31], v[80:83], v[56:59], v[28:31]
  ds_read_b128 v[52:55], v8 offset:1024
  v_mfma_f32_16x16x32_bf16 v[32:35], v[84:87], v[56:59], v[32:35]
  v_mfma_f32_16x16x32_bf16 v[36:39], v[88:91], v[56:59], v[36:39]
  s_waitcnt lgkmcnt(4)
  v_mfma_f32_16x16x32_bf16 v[28:31], v[92:95], v[60:63], v[28:31]
  ds_read_b128 v[56:59], v8 offset:2048
  v_mfma_f32_16x16x32_bf16 v[32:35], v[96:99], v[60:63], v[32:35]
  v_mfma_f32_16x16x32_bf16 v[36:39], v[100:103], v[60:63], v[36:39]
  s_waitcnt lgkmcnt(4)
  v_mfma_f32_16x16x32_bf16 v[28:31], v[104:107], v[40:43], v[28:31]
  ds_read_b128 v[60:63], v8 offset:3072
  v_mfma_f32_16x16x32_bf16 v[32:35], v[108:111], v[40:43], v[32:35]
  v_mfma_f32_16x16x32_bf16 v[36:39], v[112:115], v[40:43], v[36:39]
  s_waitcnt lgkmcnt(4)
  v_mfma_f32_16x16x32_bf16 v[28:31], v[116:119], v[44:47], v[28:31]
  ds_read_b128 v[40:43], v8 offset:4096
  v_mfma_f32_16x16x32_bf16 v[32:35], v[120:123], v[44:47], v[32:35]
  v_mfma_f32_16x16x32_bf16 v[36:39], v[124:127], v[44:47], v[36:39]
  s_waitcnt lgkmcnt(4)
  v_mfma_f32_16x16x32_bf16 v[16:19], a[0:3], v[48:51], 0
  ds_read_b128 v[44:47], v8 offset:5120
  v_mfma_f32_16x16x32_bf16 v[20:23], a[4:7], v[48:51], 0
  v_mfma_f32_16x16x32_bf16 v[24:27], a[8:11], v[48:51], 0
  s_waitcnt lgkmcnt(4)
  v_mfma_f32_16x16x32_bf16 v[16:19], a[12:15], v[52:55], v[16:19]
  ds_read_b128 v[48:51], v8 offset:6144
  v_mfma_f32_16x16x32_bf16 v[20:23], a[16:19], v[52:55], v[20:23]
  v_mfma_f32_16x16x32_bf16 v[24:27], a[20:23], v[52:55], v[24:27]
  s_waitcnt lgkmcnt(4)
  v_mfma_f32_16x16x32_bf16 v[16:19], a[24:27], v[56:59], v[16:19]
  ds_read_b128 v[52:55], v8 offset:7168
  v_mfma_f32_16x16x32_bf16 v[20:23], a[28:31], v[56:59], v[20:23]
  ds_write_addtid_b32 v28 offset:12288
  v_mfma_f32_16x16x32_bf16 v[24:27], a[32:35], v[56:59], v[24:27]
  ds_write_addtid_b32 v29 offset:12544
  s_waitcnt lgkmcnt(6)
  v_mfma_f32_16x16x32_bf16 v[16:19], a[36:39], v[60:63], v[16:19]
  ds_read_b128 v[56:59], v8 offset:8192
  v_mfma_f32_16x16x32_bf16 v[20:23], a[40:43], v[60:63], v[20:23]
  ds_write_addtid_b32 v30 offset:12800
  v_mfma_f32_16x16x32_bf16 v[24:27], a[44:47], v[60:63], v[24:27]
  ds_write_addtid_b32 v31 offset:13056
  s_waitcnt lgkmcnt(8)
  v_mfma_f32_16x16x32_bf16 v[16:19], a[48:51], v[40:43], v[16:19]
  ds_read_b128 v[60:63], v8 offset:9216
  v_mfma_f32_16x16x32_bf16 v[20:23], a[52:55], v[40:43], v[20:23]
  ds_write_addtid_b32 v32 offset:13312
  v_mfma_f32_16x16x32_bf16 v[24:27], a[56:59], v[40:43], v[24:27]
  ds_write_addtid_b32 v33 offset:13568
  s_waitcnt lgkmcnt(10)
  v_mfma_f32_16x16x32_bf16 v[16:19], a[60:63], v[44:47], v[16:19]
  ds_read_b128 v[40:43], v8 offset:10240
  v_mfma_f32_16x16x32_bf16 v[20:23], a[64:67], v[44:47], v[20:23]
  ds_write_addtid_b32 v34 offset:13824
  v_mfma_f32_16x16x32_bf16 v[24:27], a[68:71], v[44:47], v[24:27]
  ds_write_addtid_b32 v35 offset:14080
  s_waitcnt lgkmcnt(12)
  v_mfma_f32_16x16x32_bf16 v[16:19], a[72:75], v[48:51], v[16:19]
  ds_read_b128 v[44:47], v8 offset:11264
  v_mfma_f32_16x16x32_bf16 v[20:23], a[76:79], v[48:51], v[20:23]
  ds_write_addtid_b32 v36 offset:14336
  v_mfma_f32_16x16x32_bf16 v[24:27], a[80:83], v[48:51], v[24:27]
  ds_write_addtid_b32 v37 offset:14592
  s_waitcnt lgkmcnt(14)
  v_mfma_f32_16x16x32_bf16 v[16:19], a[84:87], v[52:55], v[16:19]
  ds_read_b128 v[48:51], v8 offset:12288
  v_mfma_f32_16x16x32_bf16 v[20:23], a[88:91], v[52:55], v[20:23]
  ds_write_addtid_b32 v38 offset:14848
  v_mfma_f32_16x16x32_bf16 v[24:27], a[92:95], v[52:55], v[24:27]
  ds_write_addtid_b32 v39 offset:15104
  s_waitcnt lgkmcnt(14)
  v_mfma_f32_16x16x32_bf16 v[16:19], a[96:99], v[56:59], v[16:19]
  ds_read_b128 v[52:55], v8 offset:13312
  v_mfma_f32_16x16x32_bf16 v[20:23], a[100:103], v[56:59], v[20:23]
  v_mfma_f32_16x16x32_bf16 v[24:27], a[104:107], v[56:59], v[24:27]
  s_waitcnt lgkmcnt(12)
  v_mfma_f32_16x16x32_bf16 v[16:19], a[108:111], v[60:63], v[16:19]
  ds_read_b128 v[56:59], v8 offset:14336
  v_mfma_f32_16x16x32_bf16 v[20:23], a[112:115], v[60:63], v[20:23]
  v_mfma_f32_16x16x32_bf16 v[24:27], a[116:119], v[60:63], v[24:27]
  s_waitcnt lgkmcnt(2)
  s_barrier
  v_mfma_f32_16x16x32_bf16 v[16:19], a[120:123], v[40:43], v[16:19]
  ds_read_b128 v[60:63], v8 offset:15360
  v_mfma_f32_16x16x32_bf16 v[20:23], a[124:127], v[40:43], v[20:23]
  v_mfma_f32_16x16x32_bf16 v[24:27], v[64:67], v[40:43], v[24:27]
  v_mfma_f32_16x16x32_bf16 v[16:19], v[68:71], v[44:47], v[16:19]
  ds_read_b128 v[40:43], v8 offset:16384
  v_mfma_f32_16x16x32_bf16 v[20:23], v[72:75], v[44:47], v[20:23]
  v_mfma_f32_16x16x32_bf16 v[24:27], v[76:79], v[44:47], v[24:27]
  v_mfma_f32_16x16x32_bf16 v[16:19], v[80:83], v[48:51], v[16:19]
  ds_read_b128 v[44:47], v8 offset:17408
  v_mfma_f32_16x16x32_bf16 v[20:23], v[84:87], v[48:51], v[20:23]
  v_mfma_f32_16x16x32_bf16 v[24:27], v[88:91], v[48:51], v[24:27]
  s_waitcnt lgkmcnt(4)
  v_mfma_f32_16x16x32_bf16 v[16:19], v[92:95], v[52:55], v[16:19]
  ds_read_b128 v[48:51], v8 offset:18432
  v_mfma_f32_16x16x32_bf16 v[20:23], v[96:99], v[52:55], v[20:23]
  v_mfma_f32_16x16x32_bf16 v[24:27], v[100:103], v[52:55], v[24:27]
  s_waitcnt lgkmcnt(4)
  v_mfma_f32_16x16x32_bf16 v[16:19], v[104:107], v[56:59], v[16:19]
  ds_read_b128 v[52:55], v8 offset:19456
  v_mfma_f32_16x16x32_bf16 v[20:23], v[108:111], v[56:59], v[20:23]
  v_mfma_f32_16x16x32_bf16 v[24:27], v[112:115], v[56:59], v[24:27]
  s_waitcnt lgkmcnt(4)
  v_mfma_f32_16x16x32_bf16 v[16:19], v[116:119], v[60:63], v[16:19]
  ds_read_b128 v[56:59], v8 offset:20480
  v_mfma_f32_16x16x32_bf16 v[20:23], v[120:123], v[60:63], v[20:23]
  v_mfma_f32_16x16x32_bf16 v[24:27], v[124:127], v[60:63], v[24:27]
  s_waitcnt lgkmcnt(4)
  v_mfma_f32_16x16x32_bf16 v[28:31], a[0:3], v[40:43], 0
  ds_read_b128 v[60:63], v8 offset:21504
  v_mfma_f32_16x16x32_bf16 v[32:35], a[4:7], v[40:43], 0
  v_mfma_f32_16x16x32_bf16 v[36:39], a[8:11], v[40:43], 0
  s_waitcnt lgkmcnt(4)
  v_mfma_f32_16x16x32_bf16 v[28:31], a[12:15], v[44:47], v[28:31]
  ds_read_b128 v[40:43], v8 offset:22528
  v_mfma_f32_16x16x32_bf16 v[32:35], a[16:19], v[44:47], v[32:35]
  v_mfma_f32_16x16x32_bf16 v[36:39], a[20:23], v[44:47], v[36:39]
  s_waitcnt lgkmcnt(4)
  v_mfma_f32_16x16x32_bf16 v[28:31], a[24:27], v[48:51], v[28:31]
  ds_read_b128 v[44:47], v8 offset:23552
  v_mfma_f32_16x16x32_bf16 v[32:35], a[28:31], v[48:51], v[32:35]
  ds_write_addtid_b32 v16 offset:0
  v_mfma_f32_16x16x32_bf16 v[36:39], a[32:35], v[48:51], v[36:39]
  ds_write_addtid_b32 v17 offset:256
  s_waitcnt lgkmcnt(6)
  v_mfma_f32_16x16x32_bf16 v[28:31], a[36:39], v[52:55], v[28:31]
  ds_read_b128 v[48:51], v8 offset:24576
  v_mfma_f32_16x16x32_bf16 v[32:35], a[40:43], v[52:55], v[32:35]
  ds_write_addtid_b32 v18 offset:512
  v_mfma_f32_16x16x32_bf16 v[36:39], a[44:47], v[52:55], v[36:39]
  ds_write_addtid_b32 v19 offset:768
  s_waitcnt lgkmcnt(8)
  v_mfma_f32_16x16x32_bf16 v[28:31], a[48:51], v[56:59], v[28:31]
  ds_read_b128 v[52:55], v8 offset:25600
  v_mfma_f32_16x16x32_bf16 v[32:35], a[52:55], v[56:59], v[32:35]
  ds_write_addtid_b32 v20 offset:1024
  v_mfma_f32_16x16x32_bf16 v[36:39], a[56:59], v[56:59], v[36:39]
  ds_write_addtid_b32 v21 offset:1280
  s_waitcnt lgkmcnt(10)
  v_mfma_f32_16x16x32_bf16 v[28:31], a[60:63], v[60:63], v[28:31]
  ds_read_b128 v[56:59], v8 offset:26624
  v_mfma_f32_16x16x32_bf16 v[32:35], a[64:67], v[60:63], v[32:35]
  ds_write_addtid_b32 v22 offset:1536
  v_mfma_f32_16x16x32_bf16 v[36:39], a[68:71], v[60:63], v[36:39]
  ds_write_addtid_b32 v23 offset:1792
  s_waitcnt lgkmcnt(12)
  v_mfma_f32_16x16x32_bf16 v[28:31], a[72:75], v[40:43], v[28:31]
  ds_read_b128 v[60:63], v8 offset:27648
  v_mfma_f32_16x16x32_bf16 v[32:35], a[76:79], v[40:43], v[32:35]
  ds_write_addtid_b32 v24 offset:2048
  v_mfma_f32_16x16x32_bf16 v[36:39], a[80:83], v[40:43], v[36:39]
  ds_write_addtid_b32 v25 offset:2304
  s_waitcnt lgkmcnt(14)
  v_mfma_f32_16x16x32_bf16 v[28:31], a[84:87], v[44:47], v[28:31]
  ds_read_b128 v[40:43], v8 offset:28672
  v_mfma_f32_16x16x32_bf16 v[32:35], a[88:91], v[44:47], v[32:35]
  ds_write_addtid_b32 v26 offset:2560
  v_mfma_f32_16x16x32_bf16 v[36:39], a[92:95], v[44:47], v[36:39]
  ds_write_addtid_b32 v27 offset:2816
  s_waitcnt lgkmcnt(14)
  v_mfma_f32_16x16x32_bf16 v[28:31], a[96:99], v[48:51], v[28:31]
  ds_read_b128 v[44:47], v8 offset:29696
  v_mfma_f32_16x16x32_bf16 v[32:35], a[100:103], v[48:51], v[32:35]
  v_mfma_f32_16x16x32_bf16 v[36:39], a[104:107], v[48:51], v[36:39]
  s_waitcnt lgkmcnt(12)
  v_mfma_f32_16x16x32_bf16 v[28:31], a[108:111], v[52:55], v[28:31]
  ds_read_b128 v[48:51], v8 offset:30720
  v_mfma_f32_16x16x32_bf16 v[32:35], a[112:115], v[52:55], v[32:35]
  v_mfma_f32_16x16x32_bf16 v[36:39], a[116:119], v[52:55], v[36:39]
  s_waitcnt lgkmcnt(2)
  s_barrier
  v_mfma_f32_16x16x32_bf16 v[28:31], a[120:123], v[56:59], v[28:31]
  ds_read_b128 v[52:55], v8 offset:31744
  v_mfma_f32_16x16x32_bf16 v[32:35], a[124:127], v[56:59], v[32:35]
  v_mfma_f32_16x16x32_bf16 v[36:39], v[64:67], v[56:59], v[36:39]
  v_mfma_f32_16x16x32_bf16 v[28:31], v[68:71], v[60:63], v[28:31]
  ds_read_b128 v[56:59], v8 offset:32768
  v_mfma_f32_16x16x32_bf16 v[32:35], v[72:75], v[60:63], v[32:35]
  v_mfma_f32_16x16x32_bf16 v[36:39], v[76:79], v[60:63], v[36:39]
  v_mfma_f32_16x16x32_bf16 v[28:31], v[80:83], v[40:43], v[28:31]
  ds_read_b128 v[60:63], v8 offset:33792
  v_mfma_f32_16x16x32_bf16 v[32:35], v[84:87], v[40:43], v[32:35]
  v_mfma_f32_16x16x32_bf16 v[36:39], v[88:91], v[40:43], v[36:39]
  s_waitcnt lgkmcnt(4)
  v_mfma_f32_16x16x32_bf16 v[28:31], v[92:95], v[44:47], v[28:31]
  ds_read_b128 v[40:43], v8 offset:34816
  v_mfma_f32_16x16x32_bf16 v[32:35], v[96:99], v[44:47], v[32:35]
  v_mfma_f32_16x16x32_bf16 v[36:39], v[100:103], v[44:47], v[36:39]
  s_waitcnt lgkmcnt(4)
  v_mfma_f32_16x16x32_bf16 v[28:31], v[104:107], v[48:51], v[28:31]
  ds_read_b128 v[44:47], v8 offset:35840
  v_mfma_f32_16x16x32_bf16 v[32:35], v[108:111], v[48:51], v[32:35]
  v_mfma_f32_16x16x32_bf16 v[36:39], v[112:115], v[48:51], v[36:39]
  s_waitcnt lgkmcnt(4)
  v_mfma_f32_16x16x32_bf16 v[28:31], v[116:119], v[52:55], v[28:31]
  ds_read_b128 v[48:51], v8 offset:36864
  v_mfma_f32_16x16x32_bf16 v[32:35], v[120:123], v[52:55], v[32:35]
  v_mfma_f32_16x16x32_bf16 v[36:39], v[124:127], v[52:55], v[36:39]
  s_waitcnt lgkmcnt(4)
  v_mfma_f32_16x16x32_bf16 v[16:19], a[0:3], v[56:59], 0
  ds_read_b128 v[52:55], v8 offset:37888
  v_mfma_f32_16x16x32_bf16 v[20:23], a[4:7], v[56:59], 0
  v_mfma_f32_16x16x32_bf16 v[24:27], a[8:11], v[56:59], 0
  s_waitcnt lgkmcnt(4)
  v_mfma_f32_16x16x32_bf16 v[16:19], a[12:15], v[60:63], v[16:19]
  ds_read_b128 v[56:59], v8 offset:38912
  v_mfma_f32_16x16x32_bf16 v[20:23], a[16:19], v[60:63], v[20:23]
  v_mfma_f32_16x16x32_bf16 v[24:27], a[20:23], v[60:63], v[24:27]
  s_waitcnt lgkmcnt(4)
  v_mfma_f32_16x16x32_bf16 v[16:19], a[24:27], v[40:43], v[16:19]
  ds_read_b128 v[60:63], v8 offset:39936
  v_mfma_f32_16x16x32_bf16 v[20:23], a[28:31], v[40:43], v[20:23]
  ds_write_addtid_b32 v28 offset:12288
  v_mfma_f32_16x16x32_bf16 v[24:27], a[32:35], v[40:43], v[24:27]
  ds_write_addtid_b32 v29 offset:12544
  s_waitcnt lgkmcnt(6)
  v_mfma_f32_16x16x32_bf16 v[16:19], a[36:39], v[44:47], v[16:19]
  ds_read_b128 v[40:43], v8 offset:40960
  v_mfma_f32_16x16x32_bf16 v[20:23], a[40:43], v[44:47], v[20:23]
  ds_write_addtid_b32 v30 offset:12800
  v_mfma_f32_16x16x32_bf16 v[24:27], a[44:47], v[44:47], v[24:27]
  ds_write_addtid_b32 v31 offset:13056
  s_waitcnt lgkmcnt(8)
  v_mfma_f32_16x16x32_bf16 v[16:19], a[48:51], v[48:51], v[16:19]
  ds_read_b128 v[44:47], v8 offset:41984
  v_mfma_f32_16x16x32_bf16 v[20:23], a[52:55], v[48:51], v[20:23]
  ds_write_addtid_b32 v32 offset:13312
  v_mfma_f32_16x16x32_bf16 v[24:27], a[56:59], v[48:51], v[24:27]
  ds_write_addtid_b32 v33 offset:13568
  s_waitcnt lgkmcnt(10)
  v_mfma_f32_16x16x32_bf16 v[16:19], a[60:63], v[52:55], v[16:19]
  ds_read_b128 v[48:51], v8 offset:43008
  v_mfma_f32_16x16x32_bf16 v[20:23], a[64:67], v[52:55], v[20:23]
  ds_write_addtid_b32 v34 offset:13824
  v_mfma_f32_16x16x32_bf16 v[24:27], a[68:71], v[52:55], v[24:27]
  ds_write_addtid_b32 v35 offset:14080
  s_waitcnt lgkmcnt(12)
  v_mfma_f32_16x16x32_bf16 v[16:19], a[72:75], v[56:59], v[16:19]
  ds_read_b128 v[52:55], v8 offset:44032
  v_mfma_f32_16x16x32_bf16 v[20:23], a[76:79], v[56:59], v[20:23]
  ds_write_addtid_b32 v36 offset:14336
  v_mfma_f32_16x16x32_bf16 v[24:27], a[80:83], v[56:59], v[24:27]
  ds_write_addtid_b32 v37 offset:14592
  s_waitcnt lgkmcnt(14)
  v_mfma_f32_16x16x32_bf16 v[16:19], a[84:87], v[60:63], v[16:19]
  ds_read_b128 v[56:59], v8 offset:45056
  v_mfma_f32_16x16x32_bf16 v[20:23], a[88:91], v[60:63], v[20:23]
  ds_write_addtid_b32 v38 offset:14848
  v_mfma_f32_16x16x32_bf16 v[24:27], a[92:95], v[60:63], v[24:27]
  ds_write_addtid_b32 v39 offset:15104
  s_waitcnt lgkmcnt(14)
  v_mfma_f32_16x16x32_bf16 v[16:19], a[96:99], v[40:43], v[16:19]
  ds_read_b128 v[60:63], v8 offset:46080
  v_mfma_f32_16x16x32_bf16 v[20:23], a[100:103], v[40:43], v[20:23]
  v_mfma_f32_16x16x32_bf16 v[24:27], a[104:107], v[40:43], v[24:27]
  s_waitcnt lgkmcnt(12)
  v_mfma_f32_16x16x32_bf16 v[16:19], a[108:111], v[44:47], v[16:19]
  ds_read_b128 v[40:43], v8 offset:47104
  v_mfma_f32_16x16x32_bf16 v[20:23], a[112:115], v[44:47], v[20:23]
  v_mfma_f32_16x16x32_bf16 v[24:27], a[116:119], v[44:47], v[24:27]
  s_waitcnt lgkmcnt(2)
  s_barrier
  v_mfma_f32_16x16x32_bf16 v[16:19], a[120:123], v[48:51], v[16:19]
  ds_read_b128 v[44:47], v8 offset:48128
  v_mfma_f32_16x16x32_bf16 v[20:23], a[124:127], v[48:51], v[20:23]
  v_mfma_f32_16x16x32_bf16 v[24:27], v[64:67], v[48:51], v[24:27]
  v_mfma_f32_16x16x32_bf16 v[16:19], v[68:71], v[52:55], v[16:19]
  ds_read_b128 v[48:51], v8 offset:49152
  v_mfma_f32_16x16x32_bf16 v[20:23], v[72:75], v[52:55], v[20:23]
  v_mfma_f32_16x16x32_bf16 v[24:27], v[76:79], v[52:55], v[24:27]
  v_mfma_f32_16x16x32_bf16 v[16:19], v[80:83], v[56:59], v[16:19]
  ds_read_b128 v[52:55], v8 offset:50176
  v_mfma_f32_16x16x32_bf16 v[20:23], v[84:87], v[56:59], v[20:23]
  v_mfma_f32_16x16x32_bf16 v[24:27], v[88:91], v[56:59], v[24:27]
  s_waitcnt lgkmcnt(4)
  v_mfma_f32_16x16x32_bf16 v[16:19], v[92:95], v[60:63], v[16:19]
  ds_read_b128 v[56:59], v8 offset:51200
  v_mfma_f32_16x16x32_bf16 v[20:23], v[96:99], v[60:63], v[20:23]
  v_mfma_f32_16x16x32_bf16 v[24:27], v[100:103], v[60:63], v[24:27]
  s_waitcnt lgkmcnt(4)
  v_mfma_f32_16x16x32_bf16 v[16:19], v[104:107], v[40:43], v[16:19]
  ds_read_b128 v[60:63], v8 offset:52224
  v_mfma_f32_16x16x32_bf16 v[20:23], v[108:111], v[40:43], v[20:23]
  v_mfma_f32_16x16x32_bf16 v[24:27], v[112:115], v[40:43], v[24:27]
  s_waitcnt lgkmcnt(4)
  v_mfma_f32_16x16x32_bf16 v[16:19], v[116:119], v[44:47], v[16:19]
  ds_read_b128 v[40:43], v8 offset:53248
  v_mfma_f32_16x16x32_bf16 v[20:23], v[120:123], v[44:47], v[20:23]
  v_mfma_f32_16x16x32_bf16 v[24:27], v[124:127], v[44:47], v[24:27]
  s_waitcnt lgkmcnt(4)
  v_mfma_f32_16x16x32_bf16 v[28:31], a[0:3], v[48:51], 0
  ds_read_b128 v[44:47], v8 offset:54272
  v_mfma_f32_16x16x32_bf16 v[32:35], a[4:7], v[48:51], 0
  v_mfma_f32_16x16x32_bf16 v[36:39], a[8:11], v[48:51], 0
  s_waitcnt lgkmcnt(4)
  v_mfma_f32_16x16x32_bf16 v[28:31], a[12:15], v[52:55], v[28:31]
  ds_read_b128 v[48:51], v8 offset:55296
  v_mfma_f32_16x16x32_bf16 v[32:35], a[16:19], v[52:55], v[32:35]
  v_mfma_f32_16x16x32_bf16 v[36:39], a[20:23], v[52:55], v[36:39]
  s_waitcnt lgkmcnt(4)
  v_mfma_f32_16x16x32_bf16 v[28:31], a[24:27], v[56:59], v[28:31]
  ds_read_b128 v[52:55], v8 offset:56320
  v_mfma_f32_16x16x32_bf16 v[32:35], a[28:31], v[56:59], v[32:35]
  ds_write_addtid_b32 v16 offset:0
  v_mfma_f32_16x16x32_bf16 v[36:39], a[32:35], v[56:59], v[36:39]
  ds_write_addtid_b32 v17 offset:256
  s_waitcnt lgkmcnt(6)
  v_mfma_f32_16x16x32_bf16 v[28:31], a[36:39], v[60:63], v[28:31]
  ds_read_b128 v[56:59], v8 offset:57344
  v_mfma_f32_16x16x32_bf16 v[32:35], a[40:43], v[60:63], v[32:35]
  ds_write_addtid_b32 v18 offset:512
  v_mfma_f32_16x16x32_bf16 v[36:39], a[44:47], v[60:63], v[36:39]
  ds_write_addtid_b32 v19 offset:768
  s_waitcnt lgkmcnt(8)
  v_mfma_f32_16x16x32_bf16 v[28:31], a[48:51], v[40:43], v[28:31]
  ds_read_b128 v[60:63], v8 offset:58368
  v_mfma_f32_16x16x32_bf16 v[32:35], a[52:55], v[40:43], v[32:35]
  ds_write_addtid_b32 v20 offset:1024
  v_mfma_f32_16x16x32_bf16 v[36:39], a[56:59], v[40:43], v[36:39]
  ds_write_addtid_b32 v21 offset:1280
  s_waitcnt lgkmcnt(10)
  v_mfma_f32_16x16x32_bf16 v[28:31], a[60:63], v[44:47], v[28:31]
  ds_read_b128 v[40:43], v8 offset:59392
  v_mfma_f32_16x16x32_bf16 v[32:35], a[64:67], v[44:47], v[32:35]
  ds_write_addtid_b32 v22 offset:1536
  v_mfma_f32_16x16x32_bf16 v[36:39], a[68:71], v[44:47], v[36:39]
  ds_write_addtid_b32 v23 offset:1792
  s_waitcnt lgkmcnt(12)
  v_mfma_f32_16x16x32_bf16 v[28:31], a[72:75], v[48:51], v[28:31]
  ds_read_b128 v[44:47], v8 offset:60416
  v_mfma_f32_16x16x32_bf16 v[32:35], a[76:79], v[48:51], v[32:35]
  ds_write_addtid_b32 v24 offset:2048
  v_mfma_f32_16x16x32_bf16 v[36:39], a[80:83], v[48:51], v[36:39]
  ds_write_addtid_b32 v25 offset:2304
  s_waitcnt lgkmcnt(14)
  v_mfma_f32_16x16x32_bf16 v[28:31], a[84:87], v[52:55], v[28:31]
  ds_read_b128 v[48:51], v8 offset:61440
  v_mfma_f32_16x16x32_bf16 v[32:35], a[88:91], v[52:55], v[32:35]
  ds_write_addtid_b32 v26 offset:2560
  v_mfma_f32_16x16x32_bf16 v[36:39], a[92:95], v[52:55], v[36:39]
  ds_write_addtid_b32 v27 offset:2816
  s_waitcnt lgkmcnt(14)
  v_mfma_f32_16x16x32_bf16 v[28:31], a[96:99], v[56:59], v[28:31]
  ds_read_b128 v[52:55], v8 offset:62464
  v_mfma_f32_16x16x32_bf16 v[32:35], a[100:103], v[56:59], v[32:35]
  v_mfma_f32_16x16x32_bf16 v[36:39], a[104:107], v[56:59], v[36:39]
  s_waitcnt lgkmcnt(12)
  v_mfma_f32_16x16x32_bf16 v[28:31], a[108:111], v[60:63], v[28:31]
  ds_read_b128 v[56:59], v8 offset:63488
  v_mfma_f32_16x16x32_bf16 v[32:35], a[112:115], v[60:63], v[32:35]
  v_mfma_f32_16x16x32_bf16 v[36:39], a[116:119], v[60:63], v[36:39]
  s_waitcnt lgkmcnt(2)
  s_barrier
  v_mfma_f32_16x16x32_bf16 v[28:31], a[120:123], v[40:43], v[28:31]
  ds_read_b128 v[60:63], v8 offset:64512
  v_mfma_f32_16x16x32_bf16 v[32:35], a[124:127], v[40:43], v[32:35]
  v_mfma_f32_16x16x32_bf16 v[36:39], v[64:67], v[40:43], v[36:39]
  v_mfma_f32_16x16x32_bf16 v[28:31], v[68:71], v[44:47], v[28:31]
  ds_read_b128 v[40:43], v7 offset:0
  v_mfma_f32_16x16x32_bf16 v[32:35], v[72:75], v[44:47], v[32:35]
  v_mfma_f32_16x16x32_bf16 v[36:39], v[76:79], v[44:47], v[36:39]
  v_mfma_f32_16x16x32_bf16 v[28:31], v[80:83], v[48:51], v[28:31]
  ds_read_b128 v[44:47], v7 offset:1024
  v_mfma_f32_16x16x32_bf16 v[32:35], v[84:87], v[48:51], v[32:35]
  v_mfma_f32_16x16x32_bf16 v[36:39], v[88:91], v[48:51], v[36:39]
  s_waitcnt lgkmcnt(4)
  v_mfma_f32_16x16x32_bf16 v[28:31], v[92:95], v[52:55], v[28:31]
  ds_read_b128 v[48:51], v7 offset:2048
  v_mfma_f32_16x16x32_bf16 v[32:35], v[96:99], v[52:55], v[32:35]
  v_mfma_f32_16x16x32_bf16 v[36:39], v[100:103], v[52:55], v[36:39]
  s_waitcnt lgkmcnt(4)
  v_mfma_f32_16x16x32_bf16 v[28:31], v[104:107], v[56:59], v[28:31]
  ds_read_b128 v[52:55], v7 offset:3072
  v_mfma_f32_16x16x32_bf16 v[32:35], v[108:111], v[56:59], v[32:35]
  v_mfma_f32_16x16x32_bf16 v[36:39], v[112:115], v[56:59], v[36:39]
  s_waitcnt lgkmcnt(4)
  v_mfma_f32_16x16x32_bf16 v[28:31], v[116:119], v[60:63], v[28:31]
  ds_read_b128 v[56:59], v7 offset:4096
  v_mfma_f32_16x16x32_bf16 v[32:35], v[120:123], v[60:63], v[32:35]
  v_mfma_f32_16x16x32_bf16 v[36:39], v[124:127], v[60:63], v[36:39]
  s_waitcnt lgkmcnt(4)
  v_mfma_f32_16x16x32_bf16 v[16:19], a[0:3], v[40:43], 0
  ds_read_b128 v[60:63], v7 offset:5120
  v_mfma_f32_16x16x32_bf16 v[20:23], a[4:7], v[40:43], 0
  v_mfma_f32_16x16x32_bf16 v[24:27], a[8:11], v[40:43], 0
  s_waitcnt lgkmcnt(4)
  v_mfma_f32_16x16x32_bf16 v[16:19], a[12:15], v[44:47], v[16:19]
  ds_read_b128 v[40:43], v7 offset:6144
  v_mfma_f32_16x16x32_bf16 v[20:23], a[16:19], v[44:47], v[20:23]
  v_mfma_f32_16x16x32_bf16 v[24:27], a[20:23], v[44:47], v[24:27]
  s_waitcnt lgkmcnt(4)
  v_mfma_f32_16x16x32_bf16 v[16:19], a[24:27], v[48:51], v[16:19]
  ds_read_b128 v[44:47], v7 offset:7168
  v_mfma_f32_16x16x32_bf16 v[20:23], a[28:31], v[48:51], v[20:23]
  ds_write_addtid_b32 v28 offset:12288
  v_mfma_f32_16x16x32_bf16 v[24:27], a[32:35], v[48:51], v[24:27]
  ds_write_addtid_b32 v29 offset:12544
  s_waitcnt lgkmcnt(6)
  v_mfma_f32_16x16x32_bf16 v[16:19], a[36:39], v[52:55], v[16:19]
  ds_read_b128 v[48:51], v7 offset:8192
  v_mfma_f32_16x16x32_bf16 v[20:23], a[40:43], v[52:55], v[20:23]
  ds_write_addtid_b32 v30 offset:12800
  v_mfma_f32_16x16x32_bf16 v[24:27], a[44:47], v[52:55], v[24:27]
  ds_write_addtid_b32 v31 offset:13056
  s_waitcnt lgkmcnt(8)
  v_mfma_f32_16x16x32_bf16 v[16:19], a[48:51], v[56:59], v[16:19]
  ds_read_b128 v[52:55], v7 offset:9216
  v_mfma_f32_16x16x32_bf16 v[20:23], a[52:55], v[56:59], v[20:23]
  ds_write_addtid_b32 v32 offset:13312
  v_mfma_f32_16x16x32_bf16 v[24:27], a[56:59], v[56:59], v[24:27]
  ds_write_addtid_b32 v33 offset:13568
  s_waitcnt lgkmcnt(10)
  v_mfma_f32_16x16x32_bf16 v[16:19], a[60:63], v[60:63], v[16:19]
  ds_read_b128 v[56:59], v7 offset:10240
  v_mfma_f32_16x16x32_bf16 v[20:23], a[64:67], v[60:63], v[20:23]
  ds_write_addtid_b32 v34 offset:13824
  v_mfma_f32_16x16x32_bf16 v[24:27], a[68:71], v[60:63], v[24:27]
  ds_write_addtid_b32 v35 offset:14080
  s_waitcnt lgkmcnt(12)
  v_mfma_f32_16x16x32_bf16 v[16:19], a[72:75], v[40:43], v[16:19]
  ds_read_b128 v[60:63], v7 offset:11264
  v_mfma_f32_16x16x32_bf16 v[20:23], a[76:79], v[40:43], v[20:23]
  ds_write_addtid_b32 v36 offset:14336
  v_mfma_f32_16x16x32_bf16 v[24:27], a[80:83], v[40:43], v[24:27]
  ds_write_addtid_b32 v37 offset:14592
  s_waitcnt lgkmcnt(14)
  v_mfma_f32_16x16x32_bf16 v[16:19], a[84:87], v[44:47], v[16:19]
  ds_read_b128 v[40:43], v7 offset:12288
  v_mfma_f32_16x16x32_bf16 v[20:23], a[88:91], v[44:47], v[20:23]
  ds_write_addtid_b32 v38 offset:14848
  v_mfma_f32_16x16x32_bf16 v[24:27], a[92:95], v[44:47], v[24:27]
  ds_write_addtid_b32 v39 offset:15104
  s_waitcnt lgkmcnt(14)
  v_mfma_f32_16x16x32_bf16 v[16:19], a[96:99], v[48:51], v[16:19]
  ds_read_b128 v[44:47], v7 offset:13312
  v_mfma_f32_16x16x32_bf16 v[20:23], a[100:103], v[48:51], v[20:23]
  v_mfma_f32_16x16x32_bf16 v[24:27], a[104:107], v[48:51], v[24:27]
  s_waitcnt lgkmcnt(12)
  v_mfma_f32_16x16x32_bf16 v[16:19], a[108:111], v[52:55], v[16:19]
  ds_read_b128 v[48:51], v7 offset:14336
  v_mfma_f32_16x16x32_bf16 v[20:23], a[112:115], v[52:55], v[20:23]
  v_mfma_f32_16x16x32_bf16 v[24:27], a[116:119], v[52:55], v[24:27]
  s_waitcnt lgkmcnt(2)
  s_barrier
  v_mfma_f32_16x16x32_bf16 v[16:19], a[120:123], v[56:59], v[16:19]
  ds_read_b128 v[52:55], v7 offset:15360
  v_mfma_f32_16x16x32_bf16 v[20:23], a[124:127], v[56:59], v[20:23]
  v_mfma_f32_16x16x32_bf16 v[24:27], v[64:67], v[56:59], v[24:27]
  v_mfma_f32_16x16x32_bf16 v[16:19], v[68:71], v[60:63], v[16:19]
  ds_read_b128 v[56:59], v7 offset:16384
  v_mfma_f32_16x16x32_bf16 v[20:23], v[72:75], v[60:63], v[20:23]
  v_mfma_f32_16x16x32_bf16 v[24:27], v[76:79], v[60:63], v[24:27]
  v_mfma_f32_16x16x32_bf16 v[16:19], v[80:83], v[40:43], v[16:19]
  ds_read_b128 v[60:63], v7 offset:17408
  v_mfma_f32_16x16x32_bf16 v[20:23], v[84:87], v[40:43], v[20:23]
  v_mfma_f32_16x16x32_bf16 v[24:27], v[88:91], v[40:43], v[24:27]
  s_waitcnt lgkmcnt(4)
  v_mfma_f32_16x16x32_bf16 v[16:19], v[92:95], v[44:47], v[16:19]
  ds_read_b128 v[40:43], v7 offset:18432
  v_mfma_f32_16x16x32_bf16 v[20:23], v[96:99], v[44:47], v[20:23]
  v_mfma_f32_16x16x32_bf16 v[24:27], v[100:103], v[44:47], v[24:27]
  s_waitcnt lgkmcnt(4)
  v_mfma_f32_16x16x32_bf16 v[16:19], v[104:107], v[48:51], v[16:19]
  ds_read_b128 v[44:47], v7 offset:19456
  v_mfma_f32_16x16x32_bf16 v[20:23], v[108:111], v[48:51], v[20:23]
  v_mfma_f32_16x16x32_bf16 v[24:27], v[112:115], v[48:51], v[24:27]
  s_waitcnt lgkmcnt(4)
  v_mfma_f32_16x16x32_bf16 v[16:19], v[116:119], v[52:55], v[16:19]
  ds_read_b128 v[48:51], v7 offset:20480
  v_mfma_f32_16x16x32_bf16 v[20:23], v[120:123], v[52:55], v[20:23]
  v_mfma_f32_16x16x32_bf16 v[24:27], v[124:127], v[52:55], v[24:27]
  s_waitcnt lgkmcnt(4)
  v_mfma_f32_16x16x32_bf16 v[28:31], a[0:3], v[56:59], 0
  ds_read_b128 v[52:55], v7 offset:21504
  v_mfma_f32_16x16x32_bf16 v[32:35], a[4:7], v[56:59], 0
  v_mfma_f32_16x16x32_bf16 v[36:39], a[8:11], v[56:59], 0
  s_waitcnt lgkmcnt(4)
  v_mfma_f32_16x16x32_bf16 v[28:31], a[12:15], v[60:63], v[28:31]
  ds_read_b128 v[56:59], v7 offset:22528
  v_mfma_f32_16x16x32_bf16 v[32:35], a[16:19], v[60:63], v[32:35]
  v_mfma_f32_16x16x32_bf16 v[36:39], a[20:23], v[60:63], v[36:39]
  s_waitcnt lgkmcnt(4)
  v_mfma_f32_16x16x32_bf16 v[28:31], a[24:27], v[40:43], v[28:31]
  ds_read_b128 v[60:63], v7 offset:23552
  v_mfma_f32_16x16x32_bf16 v[32:35], a[28:31], v[40:43], v[32:35]
  ds_write_addtid_b32 v16 offset:0
  v_mfma_f32_16x16x32_bf16 v[36:39], a[32:35], v[40:43], v[36:39]
  ds_write_addtid_b32 v17 offset:256
  s_cmp_lg_u32 s64, 0
  s_cbranch_scc1 L39
  s_mov_b64 exec, 1
  buffer_atomic_add v9, v10, s[48:51], s84 offen sc0
  s_mov_b64 exec, -1
L39:
  s_waitcnt lgkmcnt(6)
  v_mfma_f32_16x16x32_bf16 v[28:31], a[36:39], v[44:47], v[28:31]
  ds_read_b128 v[40:43], v7 offset:24576
  v_mfma_f32_16x16x32_bf16 v[32:35], a[40:43], v[44:47], v[32:35]
  ds_write_addtid_b32 v18 offset:512
  v_mfma_f32_16x16x32_bf16 v[36:39], a[44:47], v[44:47], v[36:39]
  ds_write_addtid_b32 v19 offset:768
  s_waitcnt lgkmcnt(8)
  v_mfma_f32_16x16x32_bf16 v[28:31], a[48:51], v[48:51], v[28:31]
  ds_read_b128 v[44:47], v7 offset:25600
  v_mfma_f32_16x16x32_bf16 v[32:35], a[52:55], v[48:51], v[32:35]
  ds_write_addtid_b32 v20 offset:1024
  v_mfma_f32_16x16x32_bf16 v[36:39], a[56:59], v[48:51], v[36:39]
  ds_write_addtid_b32 v21 offset:1280
  s_waitcnt lgkmcnt(10)
  v_mfma_f32_16x16x32_bf16 v[28:31], a[60:63], v[52:55], v[28:31]
  ds_read_b128 v[48:51], v7 offset:26624
  v_mfma_f32_16x16x32_bf16 v[32:35], a[64:67], v[52:55], v[32:35]
  ds_write_addtid_b32 v22 offset:1536
  v_mfma_f32_16x16x32_bf16 v[36:39], a[68:71], v[52:55], v[36:39]
  ds_write_addtid_b32 v23 offset:1792
  s_waitcnt lgkmcnt(12)
  v_mfma_f32_16x16x32_bf16 v[28:31], a[72:75], v[56:59], v[28:31]
  ds_read_b128 v[52:55], v7 offset:27648
  v_mfma_f32_16x16x32_bf16 v[32:35], a[76:79], v[56:59], v[32:35]
  ds_write_addtid_b32 v24 offset:2048
  v_mfma_f32_16x16x32_bf16 v[36:39], a[80:83], v[56:59], v[36:39]
  ds_write_addtid_b32 v25 offset:2304
  s_waitcnt lgkmcnt(14)
  v_mfma_f32_16x16x32_bf16 v[28:31], a[84:87], v[60:63], v[28:31]
  ds_read_b128 v[56:59], v7 offset:28672
  v_mfma_f32_16x16x32_bf16 v[32:35], a[88:91], v[60:63], v[32:35]
  ds_write_addtid_b32 v26 offset:2560
  v_mfma_f32_16x16x32_bf16 v[36:39], a[92:95], v[60:63], v[36:39]
  ds_write_addtid_b32 v27 offset:2816
  s_waitcnt lgkmcnt(14)
  v_mfma_f32_16x16x32_bf16 v[28:31], a[96:99], v[40:43], v[28:31]
  ds_read_b128 v[60:63], v7 offset:29696
  v_mfma_f32_16x16x32_bf16 v[32:35], a[100:103], v[40:43], v[32:35]
  v_mfma_f32_16x16x32_bf16 v[36:39], a[104:107], v[40:43], v[36:39]
  s_waitcnt lgkmcnt(12)
  v_mfma_f32_16x16x32_bf16 v[28:31], a[108:111], v[44:47], v[28:31]
  ds_read_b128 v[40:43], v7 offset:30720
  v_mfma_f32_16x16x32_bf16 v[32:35], a[112:115], v[44:47], v[32:35]
  v_mfma_f32_16x16x32_bf16 v[36:39], a[116:119], v[44:47], v[36:39]
  s_waitcnt lgkmcnt(2)
  s_barrier
  v_mfma_f32_16x16x32_bf16 v[28:31], a[120:123], v[48:51], v[28:31]
  ds_read_b128 v[44:47], v7 offset:31744
  v_mfma_f32_16x16x32_bf16 v[32:35], a[124:127], v[48:51], v[32:35]
  v_mfma_f32_16x16x32_bf16 v[36:39], v[64:67], v[48:51], v[36:39]
  v_mfma_f32_16x16x32_bf16 v[28:31], v[68:71], v[52:55], v[28:31]
  v_mfma_f32_16x16x32_bf16 v[32:35], v[72:75], v[52:55], v[32:35]
  v_mfma_f32_16x16x32_bf16 v[36:39], v[76:79], v[52:55], v[36:39]
  v_mfma_f32_16x16x32_bf16 v[28:31], v[80:83], v[56:59], v[28:31]
  v_mfma_f32_16x16x32_bf16 v[32:35], v[84:87], v[56:59], v[32:35]
  v_mfma_f32_16x16x32_bf16 v[36:39], v[88:91], v[56:59], v[36:39]
  s_waitcnt lgkmcnt(2)
  v_mfma_f32_16x16x32_bf16 v[28:31], v[92:95], v[60:63], v[28:31]
  v_mfma_f32_16x16x32_bf16 v[32:35], v[96:99], v[60:63], v[32:35]
  v_mfma_f32_16x16x32_bf16 v[36:39], v[100:103], v[60:63], v[36:39]
  s_cmp_lg_u32 s64, 0
  s_cbranch_scc1 L40
  s_waitcnt vmcnt(0)
  v_readfirstlane_b32 s57, v9
  s_nop 0
  s_cmp_lg_u32 s57, 16
  s_cbranch_scc1 L41
  v_mov_b32 v5, 1
  s_mov_b64 exec, 1
  ds_add_u32 v0, v5 offset:96
  s_mov_b64 exec, -1
L41:
L40:
  s_waitcnt lgkmcnt(1)
  v_mfma_f32_16x16x32_bf16 v[28:31], v[104:107], v[40:43], v[28:31]
  v_mfma_f32_16x16x32_bf16 v[32:35], v[108:111], v[40:43], v[32:35]
  v_mfma_f32_16x16x32_bf16 v[36:39], v[112:115], v[40:43], v[36:39]
  s_waitcnt lgkmcnt(0)
  v_mfma_f32_16x16x32_bf16 v[28:31], v[116:119], v[44:47], v[28:31]
  v_mfma_f32_16x16x32_bf16 v[32:35], v[120:123], v[44:47], v[32:35]
  v_mfma_f32_16x16x32_bf16 v[36:39], v[124:127], v[44:47], v[36:39]
  s_nop 5
  ds_write_addtid_b32 v28 offset:12288
  ds_write_addtid_b32 v29 offset:12544
  ds_write_addtid_b32 v30 offset:12800
  ds_write_addtid_b32 v31 offset:13056
  ds_write_addtid_b32 v32 offset:13312
  ds_write_addtid_b32 v33 offset:13568
  ds_write_addtid_b32 v34 offset:13824
  ds_write_addtid_b32 v35 offset:14080
  ds_write_addtid_b32 v36 offset:14336
  ds_write_addtid_b32 v37 offset:14592
  ds_write_addtid_b32 v38 offset:14848
  ds_write_addtid_b32 v39 offset:15104
  ds_read2st64_b32 v[76:77], v12 offset0:48 offset1:49
  ds_read2st64_b32 v[82:83], v13 offset0:48 offset1:49
  ds_read2st64_b32 v[78:79], v12 offset0:52 offset1:53
  ds_read2st64_b32 v[84:85], v13 offset0:52 offset1:53
  ds_read2st64_b32 v[80:81], v12 offset0:56 offset1:57
  ds_read2st64_b32 v[86:87], v13 offset0:56 offset1:57
  ds_read_b128 v[64:67], v14 offset:0
  ds_read_b128 v[68:71], v14 offset:16
  ds_read_b128 v[72:75], v14 offset:32
  ds_read_b64 v[94:95], v15
  s_waitcnt lgkmcnt(0)
  s_cmp_lg_u32 s64, 0
  s_cbranch_scc1 L42
  s_cmp_eq_u32 s57, 16
  s_cbranch_scc1 L43
  s_sub_u32 s84, s84, 0
  s_mov_b32 s57, 0
  s_atomic_add s57, s[60:61], s84 glc
L43:
L42:
  v_fmac_f32 v76, v94, v64
  v_fmac_f32 v77, v94, v65
  v_fmac_f32 v78, v94, v66
  v_fmac_f32 v79, v94, v67
  v_fmac_f32 v80, v94, v68
  v_fmac_f32 v81, v94, v69
  v_mul_f32 v88, v76, v95
  v_mul_f32 v89, v77, v95
  v_mul_f32 v90, v78, v95
  v_mul_f32 v91, v79, v95
  v_mul_f32 v92, v80, v95
  v_mul_f32 v93, v81, v95
  v_exp_f32 v88, v88
  v_fmac_f32 v82, v94, v70
  v_exp_f32 v89, v89
  v_fmac_f32 v83, v94, v71
  v_exp_f32 v90, v90
  v_fmac_f32 v84, v94, v72
  v_exp_f32 v91, v91
  v_fmac_f32 v85, v94, v73
  v_exp_f32 v92, v92
  v_fmac_f32 v86, v94, v74
  v_exp_f32 v93, v93
  v_fmac_f32 v87, v94, v75
  v_add_f32 v88, 1.0, v88
  v_add_f32 v89, 1.0, v89
  v_add_f32 v90, 1.0, v90
  v_add_f32 v91, 1.0, v91
  v_add_f32 v92, 1.0, v92
  v_add_f32 v93, 1.0, v93
  v_rcp_f32 v88, v88
  v_mul_f32 v76, v76, v82
  v_rcp_f32 v89, v89
  v_mul_f32 v77, v77, v83
  v_rcp_f32 v90, v90
  v_mul_f32 v78, v78, v84
  v_rcp_f32 v91, v91
  v_mul_f32 v79, v79, v85
  v_rcp_f32 v92, v92
  v_mul_f32 v80, v80, v86
  v_rcp_f32 v93, v93
  v_mul_f32 v81, v81, v87
  v_mul_f32 v88, v88, v76
  v_mul_f32 v89, v89, v77
  v_mul_f32 v90, v90, v78
  v_mul_f32 v91, v91, v79
  v_mul_f32 v92, v92, v80
  v_mul_f32 v93, v93, v81
  v_cvt_pk_bf16_f32 v96, v88, v89
  v_cvt_pk_bf16_f32 v97, v90, v91
  v_cvt_pk_bf16_f32 v98, v92, v93
  buffer_store_dword v96, v10, s[48:51], s82 offen offset:0 sc1
  buffer_store_dword v97, v10, s[48:51], s82 offen offset:256 sc1
  buffer_store_dword v98, v10, s[48:51], s82 offen offset:512 sc1
  v_mov_b32 v5, 1
  s_mov_b64 exec, 1
  ds_add_u32 v0, v5 offset:40
  s_mov_b64 exec, -1
  s_cmp_lg_u32 s64, 0
  s_cbranch_scc1 L44
  s_waitcnt lgkmcnt(0)
  s_cmp_lg_u32 s57, 16
  s_cbranch_scc1 L45
  v_mov_b32 v5, 1
  s_mov_b64 exec, 1
  ds_add_u32 v0, v5 offset:96
  s_mov_b64 exec, -1
L45:
L44:
  s_cmp_lg_u32 s64, 2
  s_cbranch_scc1 L46
  s_sub_u32 s84, s84, 2048
  s_mov_b32 s57, 0
  s_atomic_add s57, s[60:61], s84 glc
L46:
  s_waitcnt vmcnt(0)
  v_mov_b32 v5, 1
  s_mov_b64 exec, 1
  ds_add_rtn_u32 v5, v0, v5 offset:92
  s_waitcnt lgkmcnt(0)
  v_cmp_eq_u32 vcc, 7, v5
  s_mov_b64 exec, -1
  s_cbranch_vccz L47
  s_lshl_b32 s72, s91, 7
  s_add_u32 s72, s72, 10240
  s_mov_b32 s62, 1
  s_atomic_add s62, s[60:61], s72
L47:
  s_cmp_lg_u32 s64, 0
  s_cbranch_scc1 L48
  s_waitcnt lgkmcnt(0)
  s_cmp_eq_u32 s57, 16
  s_cbranch_scc1 L49
  s_mov_b32 s79, 131072
L50:
  s_mov_b32 s56, 0
  s_atomic_add s56, s[60:61], s84 glc
  s_waitcnt lgkmcnt(0)
  s_cmp_eq_u32 s56, 16
  s_cbranch_scc1 L50d
  s_sub_u32 s79, s79, 1
  s_cbranch_scc0 L50
L50d:
L49:
  v_mov_b32 v5, 1
  s_mov_b64 exec, 1
  ds_add_u32 v0, v5 offset:96
  s_mov_b64 exec, -1
L48:
  s_cmp_lg_u32 s64, 2
  s_cbranch_scc1 L51
  s_waitcnt lgkmcnt(0)
  s_cmp_eq_u32 s57, 16
  s_cbranch_scc1 L52
  s_mov_b32 s79, 131072
L53:
  s_mov_b32 s56, 0
  s_atomic_add s56, s[60:61], s84 glc
  s_waitcnt lgkmcnt(0)
  s_cmp_eq_u32 s56, 16
  s_cbranch_scc1 L53d
  s_sub_u32 s79, s79, 1
  s_cbranch_scc0 L53
L53d:
L52:
  v_mov_b32 v5, 1
  s_mov_b64 exec, 1
  ds_add_u32 v0, v5 offset:100
  s_mov_b64 exec, -1
L51:
  s_cmp_lg_u32 s64, 3
  s_cbranch_scc1 L54
  s_sub_u32 s84, s84, 4096
  s_mov_b32 s79, 131072
L55:
  s_mov_b32 s56, 0
  s_atomic_add s56, s[60:61], s84 glc
  s_waitcnt lgkmcnt(0)
  s_cmp_eq_u32 s56, 16
  s_cbranch_scc1 L55d
  s_sub_u32 s79, s79, 1
  s_cbranch_scc0 L55
L55d:
  v_mov_b32 v5, 1
  s_mov_b64 exec, 1
  ds_add_u32 v0, v5 offset:104
  s_mov_b64 exec, -1
L54:
  s_setprio 0
  s_lshl_b32 s72, s70, 6
  v_lshl_add_u32 v7, v2, 2, s72
  v_lshlrev_b32 v9, 4, v2
  s_lshl_b32 s72, s64, 2
  v_add_u32 v2, s72, v3
  v_mul_u32_u24 v5, 264, v2
  v_add3_u32 v9, v9, v5, v0
  v_subrev_u32 v9, 139008, v9
  s_cmp_ge_u32 s70, 4
  s_cselect_b32 s75, -1, 0
  s_cselect_b32 s76, 8192, 0
  s_cselect_b32 s77, 7, 0
  s_xor_b32 s77, s77, s70
  s_lshl_b32 s73, s67, 17
  s_lshl_b32 s74, s71, 14
  s_add_u32 s73, s73, s74
  s_add_u32 s73, s73, s76
  s_lshl_b32 s74, s64, 15
  s_add_u32 s73, s73, s74
  s_add_u32 s73, s73, 3145728
  s_lshl_b32 s74, s77, 11
  s_add_u32 s82, s73, s74
  s_add_u32 s74, s74, 2048
  s_and_b32 s74, s74, 8191
  s_add_u32 s83, s73, s74
  s_sub_u32 s83, s83, 2048
  s_mul_i32 s72, s64, 3072
  s_add_u32 m0, s72, 94208
  s_lshl_b32 s73, s67, 9
  s_lshl_b32 s74, s71, 6
  s_add_u32 s89, s73, s74
  s_add_u32 s89, s89, 5505024
  v_lshlrev_b32 v8, 2, v2
  s_mov_b32 s79, 0x400000
L56:
  ds_read_b32 v5, v0 offset:96
  s_waitcnt lgkmcnt(0)
  v_cmp_gt_u32 vcc, 1, v5
  s_cbranch_vccz L57
  s_sleep 1
  s_sub_u32 s79, s79, 1
  s_cbranch_scc0 L56
L57:
  s_cmp_ge_u32 s64, 2
  s_cbranch_scc1 L58
  buffer_load_dwordx4 v4, s[48:51], s82 offen sc1 lds
  buffer_load_dwordx4 v4, s[48:51], s82 offen offset:1024 sc1 lds
  buffer_load_dwordx4 v4, s[48:51], s83 offen offset:2048 sc1 lds
  s_add_u32 m0, m0, 6144
  s_add_u32 s82, s82, 65536
  s_add_u32 s83, s83, 65536
  buffer_load_dwordx4 v4, s[48:51], s82 offen sc1 lds
  buffer_load_dwordx4 v4, s[48:51], s82 offen offset:1024 sc1 lds
  buffer_load_dwordx4 v4, s[48:51], s83 offen offset:2048 sc1 lds
L58:
  buffer_load_dword v32, v8, s[48:51], s89 offen offset:0 sc1
  buffer_load_dword v33, v8, s[48:51], s89 offen offset:128 sc1
  buffer_load_dword v34, v8, s[48:51], s89 offen offset:256 sc1
  buffer_load_dword v35, v8, s[48:51], s89 offen offset:384 sc1
  s_lshl_b32 s77, s77, 6
  v_add_u32 v5, 0, v7
  v_xor_b32 v5, s75, v5
  v_subrev_u32 v5, s75, v5
  v_subrev_u32 v5, s77, v5
  v_bfe_u32 v12, v5, 6, 1
  v_lshlrev_b32 v12, 11, v12
  v_bfe_u32 v6, v5, 1, 1
  v_lshl_add_u32 v12, v6, 10, v12
  v_bfe_u32 v6, v5, 4, 2
  v_lshl_add_u32 v12, v6, 8, v12
  v_and_b32 v6, 1, v5
  v_lshl_add_u32 v12, v6, 3, v12
  v_bfe_u32 v6, v5, 2, 2
  v_lshl_add_u32 v12, v6, 1, v12
  v_lshl_add_u32 v12, v2, 4, v12
  v_add_u32 v12, 94208, v12
  v_add_u32 v5, 1, v7
  v_xor_b32 v5, s75, v5
  v_subrev_u32 v5, s75, v5
  v_subrev_u32 v5, s77, v5
  v_bfe_u32 v13, v5, 6, 1
  v_lshlrev_b32 v13, 11, v13
  v_bfe_u32 v6, v5, 1, 1
  v_lshl_add_u32 v13, v6, 10, v13
  v_bfe_u32 v6, v5, 4, 2
  v_lshl_add_u32 v13, v6, 8, v13
  v_and_b32 v6, 1, v5
  v_lshl_add_u32 v13, v6, 3, v13
  v_bfe_u32 v6, v5, 2, 2
  v_lshl_add_u32 v13, v6, 1, v13
  v_lshl_add_u32 v13, v2, 4, v13
  v_add_u32 v13, 94208, v13
  v_add_u32 v5, 2, v7
  v_xor_b32 v5, s75, v5
  v_subrev_u32 v5, s75, v5
  v_subrev_u32 v5, s77, v5
  v_bfe_u32 v14, v5, 6, 1
  v_lshlrev_b32 v14, 11, v14
  v_bfe_u32 v6, v5, 1, 1
  v_lshl_add_u32 v14, v6, 10, v14
  v_bfe_u32 v6, v5, 4, 2
  v_lshl_add_u32 v14, v6, 8, v14
  v_and_b32 v6, 1, v5
  v_lshl_add_u32 v14, v6, 3, v14
  v_bfe_u32 v6, v5, 2, 2
  v_lshl_add_u32 v14, v6, 1, v14
  v_lshl_add_u32 v14, v2, 4, v14
  v_add_u32 v14, 94208, v14
  v_add_u32 v5, 3, v7
  v_xor_b32 v5, s75, v5
  v_subrev_u32 v5, s75, v5
  v_subrev_u32 v5, s77, v5
  v_bfe_u32 v15, v5, 6, 1
  v_lshlrev_b32 v15, 11, v15
  v_bfe_u32 v6, v5, 1, 1
  v_lshl_add_u32 v15, v6, 10, v15
  v_bfe_u32 v6, v5, 4, 2
  v_lshl_add_u32 v15, v6, 8, v15
  v_and_b32 v6, 1, v5
  v_lshl_add_u32 v15, v6, 3, v15
  v_bfe_u32 v6, v5, 2, 2
  v_lshl_add_u32 v15, v6, 1, v15
  v_lshl_add_u32 v15, v2, 4, v15
  v_add_u32 v15, 94208, v15
  s_sub_u32 s72, 32, s67
  s_cmp_eq_u32 s67, 0
  s_cselect_b32 s72, 16, s72
  s_lshl_b32 s74, s71, 19
  s_lshl_b32 s85, s67, 10
  s_mov_b32 s86, s85
  s_lshl_b32 s72, s72, 10
  s_add_u32 s87, s72, s74
  s_add_u32 s88, s87, 1048576
  v_lshlrev_b32 v10, 15, v2
  v_lshl_add_u32 v10, v7, 1, v10
  s_add_u32 s73, s71, 0
  s_lshl_b32 s72, s73, 4
  v_add_u32 v36, s72, v2
  s_cmp_lg_u32 s67, 0
  s_cbranch_scc1 L59
  s_lshl_b32 s72, s73, 3
  v_and_b32 v5, 7, v2
  v_add_u32 v5, s72, v5
  v_sub_u32 v6, 64, v5
  v_cmp_eq_u32 vcc, 0, v5
  s_nop 1
  v_cndmask_b32 v6, v6, 32, vcc
  v_cmp_gt_u32 vcc, 8, v2
  s_nop 1
  v_cndmask_b32 v36, v6, v5, vcc
L59:
  v_lshlrev_b32 v36, 15, v36
  v_lshl_add_u32 v36, v7, 1, v36
  s_add_u32 s73, s71, 2
  s_lshl_b32 s72, s73, 4
  v_add_u32 v37, s72, v2
  s_cmp_lg_u32 s67, 0
  s_cbranch_scc1 L60
  s_lshl_b32 s72, s73, 3
  v_and_b32 v5, 7, v2
  v_add_u32 v5, s72, v5
  v_sub_u32 v6, 64, v5
  v_cmp_eq_u32 vcc, 0, v5
  s_nop 1
  v_cndmask_b32 v6, v6, 32, vcc
  v_cmp_gt_u32 vcc, 8, v2
  s_nop 1
  v_cndmask_b32 v37, v6, v5, vcc
L60:
  v_lshlrev_b32 v37, 15, v37
  v_lshl_add_u32 v37, v7, 1, v37
  v_mov_b32 v16, 0
  v_mov_b32 v17, 0
  v_mov_b32 v18, 0
  v_mov_b32 v19, 0
  v_mov_b32 v20, 0
  v_mov_b32 v21, 0
  v_mov_b32 v22, 0
  v_mov_b32 v23, 0
  v_mov_b32 v24, 0
  v_mov_b32 v25, 0
  v_mov_b32 v26, 0
  v_mov_b32 v27, 0
  v_mov_b32 v28, 0
  v_mov_b32 v29, 0
  v_mov_b32 v30, 0
  v_mov_b32 v31, 0
  s_waitcnt vmcnt(0)
  s_cmp_ge_u32 s64, 2
  s_cbranch_scc1 L61
  v_mov_b32 v5, 1
  s_mov_b64 exec, 1
  ds_add_u32 v0, v5 offset:32
  s_mov_b64 exec, -1
L61:
  s_mov_b32 s79, 0x400000
L62:
  ds_read_b32 v5, v0 offset:32
  s_waitcnt lgkmcnt(0)
  v_cmp_gt_u32 vcc, 2, v5
  s_cbranch_vccz L63
  s_sleep 1
  s_sub_u32 s79, s79, 1
  s_cbranch_scc0 L62
L63:
  ds_read_u16_d16_hi v16, v12 offset:0
  ds_read_u16_d16_hi v17, v13 offset:0
  ds_read_u16_d16_hi v18, v14 offset:0
  ds_read_u16_d16_hi v19, v15 offset:0
  ds_read_u16_d16_hi v20, v12 offset:3072
  ds_read_u16_d16_hi v21, v13 offset:3072
  ds_read_u16_d16_hi v22, v14 offset:3072
  ds_read_u16_d16_hi v23, v15 offset:3072
  ds_read_u16_d16_hi v24, v12 offset:6144
  ds_read_u16_d16_hi v25, v13 offset:6144
  ds_read_u16_d16_hi v26, v14 offset:6144
  ds_read_u16_d16_hi v27, v15 offset:6144
  ds_read_u16_d16_hi v28, v12 offset:9216
  ds_read_u16_d16_hi v29, v13 offset:9216
  ds_read_u16_d16_hi v30, v14 offset:9216
  ds_read_u16_d16_hi v31, v15 offset:9216
  s_mov_b32 s79, 0x400000
L64:
  ds_read_b32 v5, v0 offset:108
  s_waitcnt lgkmcnt(0)
  v_cmp_gt_u32 vcc, 4, v5
  s_cbranch_vccz L65
  s_sleep 1
  s_sub_u32 s79, s79, 1
  s_cbranch_scc0 L64
L65:
  ds_read_b64 v[48:49], v9 offset:0
  ds_read_b64 v[50:51], v9 offset:8
  ds_read_b64 v[52:53], v9 offset:4224
  ds_read_b64 v[54:55], v9 offset:4232
  ds_read_b64 v[56:57], v9 offset:8448
  ds_read_b64 v[58:59], v9 offset:8456
  ds_read_b64 v[60:61], v9 offset:12672
  ds_read_b64 v[62:63], v9 offset:12680
  s_waitcnt lgkmcnt(4)
  v_add_f32 v48, v48, v52
  v_add_f32 v49, v49, v53
  v_add_f32 v50, v50, v54
  v_add_f32 v51, v51, v55
  s_waitcnt lgkmcnt(0)
  v_add_f32 v56, v56, v60
  v_add_f32 v57, v57, v61
  v_add_f32 v58, v58, v62
  v_add_f32 v59, v59, v63
  v_add_f32 v48, v48, v56
  v_add_f32 v49, v49, v57
  v_add_f32 v50, v50, v58
  v_add_f32 v51, v51, v59
  v_fmac_f32 v16, v48, v32
  v_fmac_f32 v17, v49, v32
  v_fmac_f32 v18, v50, v32
  v_fmac_f32 v19, v51, v32
  v_cvt_pk_bf16_f32 v40, v16, v17
  v_cvt_pk_bf16_f32 v41, v18, v19
  buffer_store_dwordx2 v[40:41], v36, s[44:47], s85 offen sc1
  s_mov_b32 s79, 0x400000
L66:
  ds_read_b32 v5, v0 offset:112
  s_waitcnt lgkmcnt(0)
  v_cmp_gt_u32 vcc, 4, v5
  s_cbranch_vccz L67
  s_sleep 1
  s_sub_u32 s79, s79, 1
  s_cbranch_scc0 L66
L67:
  ds_read_b64 v[48:49], v9 offset:16896
  ds_read_b64 v[50:51], v9 offset:16904
  ds_read_b64 v[52:53], v9 offset:21120
  ds_read_b64 v[54:55], v9 offset:21128
  ds_read_b64 v[56:57], v9 offset:25344
  ds_read_b64 v[58:59], v9 offset:25352
  ds_read_b64 v[60:61], v9 offset:29568
  ds_read_b64 v[62:63], v9 offset:29576
  s_waitcnt lgkmcnt(4)
  v_add_f32 v48, v48, v52
  v_add_f32 v49, v49, v53
  v_add_f32 v50, v50, v54
  v_add_f32 v51, v51, v55
  s_waitcnt lgkmcnt(0)
  v_add_f32 v56, v56, v60
  v_add_f32 v57, v57, v61
  v_add_f32 v58, v58, v62
  v_add_f32 v59, v59, v63
  v_add_f32 v48, v48, v56
  v_add_f32 v49, v49, v57
  v_add_f32 v50, v50, v58
  v_add_f32 v51, v51, v59
  v_fmac_f32 v20, v48, v33
  v_fmac_f32 v21, v49, v33
  v_fmac_f32 v22, v50, v33
  v_fmac_f32 v23, v51, v33
  v_cvt_pk_bf16_f32 v42, v20, v21
  v_cvt_pk_bf16_f32 v43, v22, v23
  buffer_store_dwordx2 v[42:43], v37, s[44:47], s86 offen sc1
  s_mov_b32 s79, 0x400000
L68:
  ds_read_b32 v5, v0 offset:116
  s_waitcnt lgkmcnt(0)
  v_cmp_gt_u32 vcc, 4, v5
  s_cbranch_vccz L69
  s_sleep 1
  s_sub_u32 s79, s79, 1
  s_cbranch_scc0 L68
L69:
  ds_read_b64 v[48:49], v9 offset:33792
  ds_read_b64 v[50:51], v9 offset:33800
  ds_read_b64 v[52:53], v9 offset:38016
  ds_read_b64 v[54:55], v9 offset:38024
  ds_read_b64 v[56:57], v9 offset:42240
  ds_read_b64 v[58:59], v9 offset:42248
  ds_read_b64 v[60:61], v9 offset:46464
  ds_read_b64 v[62:63], v9 offset:46472
  s_waitcnt lgkmcnt(4)
  v_add_f32 v48, v48, v52
  v_add_f32 v49, v49, v53
  v_add_f32 v50, v50, v54
  v_add_f32 v51, v51, v55
  s_waitcnt lgkmcnt(0)
  v_add_f32 v56, v56, v60
  v_add_f32 v57, v57, v61
  v_add_f32 v58, v58, v62
  v_add_f32 v59, v59, v63
  v_add_f32 v48, v48, v56
  v_add_f32 v49, v49, v57
  v_add_f32 v50, v50, v58
  v_add_f32 v51, v51, v59
  v_fmac_f32 v24, v48, v34
  v_fmac_f32 v25, v49, v34
  v_fmac_f32 v26, v50, v34
  v_fmac_f32 v27, v51, v34
  v_cvt_pk_bf16_f32 v44, v24, v25
  v_cvt_pk_bf16_f32 v45, v26, v27
  buffer_store_dwordx2 v[44:45], v10, s[44:47], s87 offen sc1
  s_setprio 2
  s_mov_b32 s79, 0x400000
L70:
  ds_read_b32 v5, v0 offset:120
  s_waitcnt lgkmcnt(0)
  v_cmp_gt_u32 vcc, 4, v5
  s_cbranch_vccz L71
  s_sub_u32 s79, s79, 1
  s_cbranch_scc0 L70
L71:
  ds_read_b64 v[48:49], v9 offset:50688
  ds_read_b64 v[50:51], v9 offset:50696
  ds_read_b64 v[52:53], v9 offset:54912
  ds_read_b64 v[54:55], v9 offset:54920
  ds_read_b64 v[56:57], v9 offset:59136
  ds_read_b64 v[58:59], v9 offset:59144
  ds_read_b64 v[60:61], v9 offset:63360
  ds_read_b64 v[62:63], v9 offset:63368
  s_waitcnt lgkmcnt(4)
  v_add_f32 v48, v48, v52
  v_add_f32 v49, v49, v53
  v_add_f32 v50, v50, v54
  v_add_f32 v51, v51, v55
  s_waitcnt lgkmcnt(0)
  v_add_f32 v56, v56, v60
  v_add_f32 v57, v57, v61
  v_add_f32 v58, v58, v62
  v_add_f32 v59, v59, v63
  v_add_f32 v48, v48, v56
  v_add_f32 v49, v49, v57
  v_add_f32 v50, v50, v58
  v_add_f32 v51, v51, v59
  v_fmac_f32 v28, v48, v35
  v_fmac_f32 v29, v49, v35
  v_fmac_f32 v30, v50, v35
  v_fmac_f32 v31, v51, v35
  v_cvt_pk_bf16_f32 v46, v28, v29
  v_cvt_pk_bf16_f32 v47, v30, v31
  buffer_store_dwordx2 v[46:47], v10, s[44:47], s88 offen sc1
  s_endpgm
Ls1:
  s_add_u32 m0, s83, 49216
  s_add_u32 s96, s80, 352256
  s_waitcnt vmcnt(9)
  buffer_load_dwordx4 v50, s[32:35], s96 offen lds
  s_add_u32 m0, s83, 61536
  s_waitcnt vmcnt(9)
  buffer_load_dwordx4 v50, s[36:39], s96 offen lds
  v_mov_b32 v5, 1
  s_mov_b64 exec, 1
  ds_add_u32 v0, v5 offset:0
  s_mov_b64 exec, -1
  s_add_u32 m0, s83, 52288
  s_add_u32 s96, s80, 355008
  s_waitcnt vmcnt(9)
  buffer_load_dwordx4 v50, s[32:35], s96 offen lds
  s_add_u32 m0, s83, 64608
  s_waitcnt vmcnt(9)
  buffer_load_dwordx4 v50, s[36:39], s96 offen lds
  s_add_u32 m0, s83, 55360
  s_add_u32 s96, s80, 357760
  s_waitcnt vmcnt(9)
  buffer_load_dwordx4 v50, s[32:35], s96 offen lds
  s_add_u32 m0, s83, 67680
  s_waitcnt vmcnt(9)
  buffer_load_dwordx4 v50, s[36:39], s96 offen lds
  s_add_u32 m0, s83, 58432
  s_add_u32 s96, s80, 360512
  s_waitcnt vmcnt(9)
  buffer_load_dwordx4 v50, s[32:35], s96 offen lds
  s_add_u32 m0, s83, 70752
  s_waitcnt vmcnt(9)
  buffer_load_dwordx4 v50, s[36:39], s96 offen lds
  s_add_u32 m0, s83, 73824
  s_add_u32 s96, s80, 528384
  s_waitcnt vmcnt(9)
  buffer_load_dwordx4 v50, s[32:35], s96 offen lds
  s_add_u32 m0, s83, 86144
  s_waitcnt vmcnt(9)
  buffer_load_dwordx4 v50, s[36:39], s96 offen lds
  v_mov_b32 v5, 1
  s_mov_b64 exec, 1
  ds_add_u32 v0, v5 offset:4
  s_mov_b64 exec, -1
  s_add_u32 m0, s83, 76896
  s_add_u32 s96, s80, 531136
  s_waitcnt vmcnt(9)
  buffer_load_dwordx4 v50, s[32:35], s96 offen lds
  s_add_u32 m0, s83, 89216
  s_waitcnt vmcnt(9)
  buffer_load_dwordx4 v50, s[36:39], s96 offen lds
  s_add_u32 m0, s83, 79968
  s_add_u32 s96, s80, 533888
  s_waitcnt vmcnt(9)
  buffer_load_dwordx4 v50, s[32:35], s96 offen lds
  s_add_u32 m0, s83, 92288
  s_waitcnt vmcnt(9)
  buffer_load_dwordx4 v50, s[36:39], s96 offen lds
  s_add_u32 m0, s83, 83040
  s_add_u32 s96, s80, 536640
  s_waitcnt vmcnt(9)
  buffer_load_dwordx4 v50, s[32:35], s96 offen lds
  s_add_u32 m0, s83, 95360
  s_waitcnt vmcnt(9)
  buffer_load_dwordx4 v50, s[36:39], s96 offen lds
  s_add_u32 m0, s83, 98432
  s_sub_u32 s96, s81, 704512
  s_waitcnt vmcnt(9)
  buffer_load_dwordx4 v52, s[32:35], s96 offen lds
  s_add_u32 m0, s83, 110752
  s_waitcnt vmcnt(9)
  buffer_load_dwordx4 v52, s[36:39], s96 offen lds
  v_mov_b32 v5, 1
  s_mov_b64 exec, 1
  ds_add_u32 v0, v5 offset:8
  s_mov_b64 exec, -1
  s_add_u32 m0, s83, 101504
  s_sub_u32 s96, s81, 2752
  s_waitcnt vmcnt(9)
  buffer_load_dwordx4 v51, s[32:35], s96 offen lds
  s_add_u32 m0, s83, 113824
  s_waitcnt vmcnt(9)
  buffer_load_dwordx4 v51, s[36:39], s96 offen lds
  s_add_u32 m0, s83, 104576
  s_sub_u32 s96, s81, 5504
  s_waitcnt vmcnt(9)
  buffer_load_dwordx4 v51, s[32:35], s96 offen lds
  s_add_u32 m0, s83, 116896
  s_waitcnt vmcnt(9)
  buffer_load_dwordx4 v51, s[36:39], s96 offen lds
  s_add_u32 m0, s83, 107648
  s_sub_u32 s96, s81, 8256
  s_waitcnt vmcnt(9)
  buffer_load_dwordx4 v51, s[32:35], s96 offen lds
  s_add_u32 m0, s83, 119968
  s_waitcnt vmcnt(9)
  buffer_load_dwordx4 v51, s[36:39], s96 offen lds
  s_mov_b32 s79, 0x400000
L74:
  ds_read_b32 v5, v0 offset:56
  s_waitcnt lgkmcnt(0)
  v_cmp_gt_u32 vcc, 4, v5
  s_cbranch_vccz L75
  s_sleep 1
  s_sub_u32 s79, s79, 1
  s_cbranch_scc0 L74
L75:
  s_add_u32 m0, s83, 123136
  s_sub_u32 s96, s81, 176128
  s_waitcnt vmcnt(9)
  buffer_load_dwordx4 v51, s[32:35], s96 offen lds
  s_add_u32 m0, s83, 135456
  s_waitcnt vmcnt(9)
  buffer_load_dwordx4 v51, s[36:39], s96 offen lds
  v_mov_b32 v5, 1
  s_mov_b64 exec, 1
  ds_add_u32 v0, v5 offset:12
  s_mov_b64 exec, -1
  s_add_u32 m0, s83, 126208
  s_sub_u32 s96, s81, 178880
  s_waitcnt vmcnt(9)
  buffer_load_dwordx4 v51, s[32:35], s96 offen lds
  s_add_u32 m0, s83, 138528
  s_waitcnt vmcnt(9)
  buffer_load_dwordx4 v51, s[36:39], s96 offen lds
  s_add_u32 m0, s83, 129280
  s_sub_u32 s96, s81, 181632
  s_waitcnt vmcnt(9)
  buffer_load_dwordx4 v51, s[32:35], s96 offen lds
  s_add_u32 m0, s83, 141600
  s_waitcnt vmcnt(9)
  buffer_load_dwordx4 v51, s[36:39], s96 offen lds
  s_add_u32 m0, s83, 132352
  s_sub_u32 s96, s81, 184384
  s_waitcnt vmcnt(9)
  buffer_load_dwordx4 v51, s[32:35], s96 offen lds
  s_add_u32 m0, s83, 144672
  s_waitcnt vmcnt(9)
  buffer_load_dwordx4 v51, s[36:39], s96 offen lds
  s_mov_b32 s79, 0x400000
L76:
  ds_read_b32 v5, v0 offset:64
  s_waitcnt lgkmcnt(0)
  v_cmp_gt_u32 vcc, 4, v5
  s_cbranch_vccz L77
  s_sleep 1
  s_sub_u32 s79, s79, 1
  s_cbranch_scc0 L76
L77:
  s_add_u32 m0, s83, 0
  s_sub_u32 s96, s81, 352256
  s_waitcnt vmcnt(9)
  buffer_load_dwordx4 v51, s[32:35], s96 offen lds
  s_add_u32 m0, s83, 12320
  s_waitcnt vmcnt(9)
  buffer_load_dwordx4 v51, s[36:39], s96 offen lds
  v_mov_b32 v5, 1
  s_mov_b64 exec, 1
  ds_add_u32 v0, v5 offset:16
  s_mov_b64 exec, -1
  s_add_u32 m0, s83, 3072
  s_sub_u32 s96, s81, 355008
  s_waitcnt vmcnt(9)
  buffer_load_dwordx4 v51, s[32:35], s96 offen lds
  s_add_u32 m0, s83, 15392
  s_waitcnt vmcnt(9)
  buffer_load_dwordx4 v51, s[36:39], s96 offen lds
  s_add_u32 m0, s83, 6144
  s_sub_u32 s96, s81, 357760
  s_waitcnt vmcnt(9)
  buffer_load_dwordx4 v51, s[32:35], s96 offen lds
  s_add_u32 m0, s83, 18464
  s_waitcnt vmcnt(9)
  buffer_load_dwordx4 v51, s[36:39], s96 offen lds
  s_add_u32 m0, s83, 9216
  s_sub_u32 s96, s81, 360512
  s_waitcnt vmcnt(9)
  buffer_load_dwordx4 v51, s[32:35], s96 offen lds
  s_add_u32 m0, s83, 21536
  s_waitcnt vmcnt(9)
  buffer_load_dwordx4 v51, s[36:39], s96 offen lds
  s_add_u32 m0, s83, 24608
  s_sub_u32 s96, s81, 528384
  s_waitcnt vmcnt(9)
  buffer_load_dwordx4 v51, s[32:35], s96 offen lds
  s_add_u32 m0, s83, 36928
  s_waitcnt vmcnt(9)
  buffer_load_dwordx4 v51, s[36:39], s96 offen lds
  v_mov_b32 v5, 1
  s_mov_b64 exec, 1
  ds_add_u32 v0, v5 offset:20
  s_mov_b64 exec, -1
  s_add_u32 m0, s83, 27680
  s_sub_u32 s96, s81, 531136
  s_waitcnt vmcnt(9)
  buffer_load_dwordx4 v51, s[32:35], s96 offen lds
  s_add_u32 m0, s83, 40000
  s_waitcnt vmcnt(9)
  buffer_load_dwordx4 v51, s[36:39], s96 offen lds
  s_add_u32 m0, s83, 30752
  s_sub_u32 s96, s81, 533888
  s_waitcnt vmcnt(9)
  buffer_load_dwordx4 v51, s[32:35], s96 offen lds
  s_add_u32 m0, s83, 43072
  s_waitcnt vmcnt(9)
  buffer_load_dwordx4 v51, s[36:39], s96 offen lds
  s_add_u32 m0, s83, 33824
  s_sub_u32 s96, s81, 536640
  s_waitcnt vmcnt(9)
  buffer_load_dwordx4 v51, s[32:35], s96 offen lds
  s_add_u32 m0, s83, 46144
  s_waitcnt vmcnt(9)
  buffer_load_dwordx4 v51, s[36:39], s96 offen lds
  s_lshl_b32 s72, s68, 17
  s_lshl_b32 s84, s64, 12
  s_add_u32 s82, s72, s84
  s_add_u32 s82, s82, 3145728
  s_add_u32 s84, s84, 24576
  s_mul_i32 s73, s70, 43
  s_mul_i32 s74, s64, 11
  s_add_u32 s73, s73, s74
  s_lshl_b32 s73, s73, 12
  s_add_u32 s86, s73, 5767168
  s_waitcnt vmcnt(0)
  v_mov_b32 v5, 1
  s_mov_b64 exec, 1
  ds_add_u32 v0, v5 offset:24
  s_mov_b64 exec, -1
  v_mov_b32 v5, 1
  s_mov_b64 exec, 1
  ds_add_u32 v0, v5 offset:28
  s_mov_b64 exec, -1
  s_lshl_b32 s73, s68, 14
  s_lshl_b32 s74, s64, 7
  s_add_u32 s80, s73, s74
  s_add_u32 s80, s80, 5242880
  v_and_b32 v5, 31, v1
  v_lshlrev_b32 v12, 2, v5
  v_and_b32 v6, 32, v1
  v_lshl_add_u32 v7, v6, 4, v12
  s_mul_i32 s73, s64, 3072
  v_add_u32 v8, s73, v7
  v_add_u32 v15, 128, v8
  v_and_b32 v5, 1, v3
  v_lshlrev_b32 v9, 3, v5
  v_lshl_add_u32 v9, v2, 4, v9
  v_lshrrev_b32 v6, 3, v6
  v_add_u32 v9, v9, v6
  v_lshlrev_b32 v10, 3, v2
  v_add_u32 v10, 156416, v10
  s_lshl_b32 s73, s64, 8
  s_add_u32 s73, s73, 156416
  v_lshl_add_u32 v11, v12, 1, s73
  s_mul_i32 s73, s68, 393216
  s_lshl_b32 s74, s90, 2
  s_add_u32 s74, s74, s64
  s_mul_i32 s74, s74, 768
  s_add_u32 s85, s73, s74
  s_add_u32 s85, s85, 7340032
  s_mov_b32 s79, 0x400000
L78:
  ds_read_b32 v5, v0 offset:36
  s_waitcnt lgkmcnt(0)
  v_cmp_gt_u32 vcc, 1, v5
  s_cbranch_vccz L79
  s_sleep 1
  s_sub_u32 s79, s79, 1
  s_cbranch_scc0 L78
L79:
  s_add_u32 s74, s86, 0
  buffer_load_dwordx4 a[0:3], v4, s[48:51], s74 offen offset:0 sc1
  buffer_load_dwordx4 a[4:7], v4, s[48:51], s74 offen offset:1024 sc1
  buffer_load_dwordx4 a[8:11], v4, s[48:51], s74 offen offset:2048 sc1
  buffer_load_dwordx4 a[12:15], v4, s[48:51], s74 offen offset:3072 sc1
  s_add_u32 s74, s86, 4096
  buffer_load_dwordx4 a[16:19], v4, s[48:51], s74 offen offset:0 sc1
  buffer_load_dwordx4 a[20:23], v4, s[48:51], s74 offen offset:1024 sc1
  buffer_load_dwordx4 a[24:27], v4, s[48:51], s74 offen offset:2048 sc1
  buffer_load_dwordx4 a[28:31], v4, s[48:51], s74 offen offset:3072 sc1
  s_add_u32 s74, s86, 8192
  buffer_load_dwordx4 a[32:35], v4, s[48:51], s74 offen offset:0 sc1
  buffer_load_dwordx4 a[36:39], v4, s[48:51], s74 offen offset:1024 sc1
  buffer_load_dwordx4 a[40:43], v4, s[48:51], s74 offen offset:2048 sc1
  buffer_load_dwordx4 a[44:47], v4, s[48:51], s74 offen offset:3072 sc1
  s_mov_b32 s79, 0x400000
L80:
  ds_read_b32 v5, v0 offset:124
  s_waitcnt lgkmcnt(0)
  v_cmp_gt_u32 vcc, 5, v5
  s_cbranch_vccz L81
  s_sleep 1
  s_sub_u32 s79, s79, 1
  s_cbranch_scc0 L80
L81:
  s_add_u32 s74, s86, 12288
  buffer_load_dwordx4 a[48:51], v4, s[48:51], s74 offen offset:0 sc1
  buffer_load_dwordx4 a[52:55], v4, s[48:51], s74 offen offset:1024 sc1
  buffer_load_dwordx4 a[56:59], v4, s[48:51], s74 offen offset:2048 sc1
  buffer_load_dwordx4 a[60:63], v4, s[48:51], s74 offen offset:3072 sc1
  s_add_u32 s74, s86, 16384
  buffer_load_dwordx4 a[64:67], v4, s[48:51], s74 offen offset:0 sc1
  buffer_load_dwordx4 a[68:71], v4, s[48:51], s74 offen offset:1024 sc1
  buffer_load_dwordx4 a[72:75], v4, s[48:51], s74 offen offset:2048 sc1
  buffer_load_dwordx4 a[76:79], v4, s[48:51], s74 offen offset:3072 sc1
  s_add_u32 s74, s86, 20480
  buffer_load_dwordx4 a[80:83], v4, s[48:51], s74 offen offset:0 sc1
  buffer_load_dwordx4 a[84:87], v4, s[48:51], s74 offen offset:1024 sc1
  buffer_load_dwordx4 a[88:91], v4, s[48:51], s74 offen offset:2048 sc1
  buffer_load_dwordx4 a[92:95], v4, s[48:51], s74 offen offset:3072 sc1
  s_branch Lh3
Lh5:
  s_lshl_b32 s72, s68, 17
  s_lshl_b32 s84, s64, 12
  s_add_u32 s82, s72, s84
  s_add_u32 s82, s82, 3145728
  s_add_u32 s84, s84, 24576
  s_mul_i32 s73, s70, 43
  s_mul_i32 s74, s64, 11
  s_add_u32 s73, s73, s74
  s_lshl_b32 s73, s73, 12
  s_add_u32 s86, s73, 5767168
  s_lshl_b32 s74, s69, 3
  s_add_u32 s74, s74, s70
  s_lshl_b32 s74, s74, 13
  s_add_u32 s80, s74, 1048576
  s_add_u32 s81, s80, 4096
  s_lshr_b32 s72, s70, 1
  s_lshl_b32 s72, s72, 2
  s_and_b32 s73, s67, 3
  s_add_u32 s72, s72, s73
  s_lshl_b32 s74, s72, 9
  s_add_u32 s75, s74, 128
  s_add_u32 s76, s74, 256
  s_add_u32 s77, s74, 384
  s_lshl_b32 s72, s66, 4
  s_and_b32 s73, s2, 3
  s_add_u32 s72, s72, s73
  s_lshl_b32 s72, s72, 7
  s_mov_b32 s62, 1
  s_mov_b32 m0, 147840
  s_waitcnt vmcnt(0)
  s_setprio 2
  s_mov_b32 s79, 0x400000
L89:
  ds_read_b32 v5, v0 offset:56
  s_waitcnt lgkmcnt(0)
  v_cmp_gt_u32 vcc, 1, v5
  s_cbranch_vccz L90
  s_sleep 1
  s_sub_u32 s79, s79, 1
  s_cbranch_scc0 L89
L90:
  s_load_dword s63, s[58:59], 0x0
  s_mov_b32 s79, 0x400000
L91:
  ds_read_b32 v5, v0 offset:68
  s_waitcnt lgkmcnt(0)
  v_cmp_gt_u32 vcc, 4, v5
  s_cbranch_vccz L92
  s_sleep 1
  s_sub_u32 s79, s79, 1
  s_cbranch_scc0 L91
L92:
  s_cmp_ge_u32 s63, 4
  s_cbranch_scc1 L93
  v_mov_b32 v6, 0
  s_mov_b32 s79, 131072
L95:
  buffer_load_dword v5, v6, s[52:55], 0 offen sc1
  s_waitcnt vmcnt(0)
  v_cmp_gt_u32 vcc, 4, v5
  s_cbranch_vccz L94
  s_sleep 8
  s_sub_u32 s79, s79, 1
  s_cbranch_scc0 L95
L94:
L93:
  s_atomic_add s62, s[60:61], s72
  s_add_u32 s72, s72, 512
  s_atomic_add s62, s[60:61], s72
  s_add_u32 s72, s72, 512
  s_atomic_add s62, s[60:61], s72
  s_add_u32 s72, s72, 512
  s_atomic_add s62, s[60:61], s72
  s_mov_b32 s79, 131072
L96:
  s_mov_b32 s56, 0
  s_mov_b32 s57, 0
  s_mov_b32 s58, 0
  s_mov_b32 s59, 0
  s_atomic_add s56, s[60:61], s74 glc
  s_atomic_add s57, s[60:61], s75 glc
  s_atomic_add s58, s[60:61], s76 glc
  s_atomic_add s59, s[60:61], s77 glc
  s_waitcnt lgkmcnt(0)
  s_add_u32 s56, s56, s57
  s_add_u32 s56, s56, s58
  s_add_u32 s56, s56, s59
  s_cmp_eq_u32 s56, 64
  s_cbranch_scc1 L96d
  s_sub_u32 s79, s79, 1
  s_cbranch_scc0 L96
L96d:
  buffer_load_dwordx4 v4, s[48:51], s80 offen offset:0 sc1 lds
  buffer_load_dwordx4 v4, s[48:51], s80 offen offset:1024 sc1 lds
  buffer_load_dwordx4 v4, s[48:51], s80 offen offset:2048 sc1 lds
  buffer_load_dwordx4 v4, s[48:51], s80 offen offset:3072 sc1 lds
  s_mov_b32 m0, 151936
  s_nop 0
  buffer_load_dwordx4 v4, s[48:51], s81 offen offset:0 sc1 lds
  buffer_load_dwordx4 v4, s[48:51], s81 offen offset:1024 sc1 lds
  buffer_load_dwordx4 v4, s[48:51], s81 offen offset:2048 sc1 lds
  buffer_load_dwordx4 v4, s[48:51], s81 offen offset:3072 sc1 lds
  v_mov_b32 v5, 1
  s_mov_b64 exec, 1
  ds_add_u32 v0, v5 offset:36
  s_mov_b64 exec, -1
  s_lshl_b32 s75, s91, 7
  s_add_u32 s75, s75, 8192
  s_waitcnt vmcnt(0)
  v_mov_b32 v5, 1
  s_mov_b64 exec, 1
  ds_add_u32 v0, v5 offset:76
  s_mov_b64 exec, -1
  s_add_u32 s74, s86, 0
  buffer_load_dwordx4 a[0:3], v4, s[48:51], s74 offen offset:0 sc1
  buffer_load_dwordx4 a[4:7], v4, s[48:51], s74 offen offset:1024 sc1
  buffer_load_dwordx4 a[8:11], v4, s[48:51], s74 offen offset:2048 sc1
  buffer_load_dwordx4 a[12:15], v4, s[48:51], s74 offen offset:3072 sc1
  s_add_u32 s74, s86, 4096
  buffer_load_dwordx4 a[16:19], v4, s[48:51], s74 offen offset:0 sc1
  buffer_load_dwordx4 a[20:23], v4, s[48:51], s74 offen offset:1024 sc1
  buffer_load_dwordx4 a[24:27], v4, s[48:51], s74 offen offset:2048 sc1
  buffer_load_dwordx4 a[28:31], v4, s[48:51], s74 offen offset:3072 sc1
  s_add_u32 s74, s86, 8192
  buffer_load_dwordx4 a[32:35], v4, s[48:51], s74 offen offset:0 sc1
  buffer_load_dwordx4 a[36:39], v4, s[48:51], s74 offen offset:1024 sc1
  buffer_load_dwordx4 a[40:43], v4, s[48:51], s74 offen offset:2048 sc1
  buffer_load_dwordx4 a[44:47], v4, s[48:51], s74 offen offset:3072 sc1
  s_lshr_b32 s72, s91, 3
  s_lshl_b32 s72, s72, 2
  s_and_b32 s73, s67, 3
  s_add_u32 s72, s72, s73
  s_lshl_b32 s72, s72, 2
  s_and_b32 s73, s91, 3
  s_add_u32 s72, s72, s73
  s_lshl_b32 s76, s72, 7
  s_add_u32 s77, s76, 4096
  s_mov_b32 s79, 131072
L97:
  s_mov_b32 s56, 0
  s_mov_b32 s57, 0
  s_atomic_add s56, s[60:61], s76 glc
  s_atomic_add s57, s[60:61], s77 glc
  s_waitcnt lgkmcnt(0)
  s_add_u32 s56, s56, s57
  s_cmp_eq_u32 s56, 32
  s_cbranch_scc1 L97d
  s_sub_u32 s79, s79, 1
  s_cbranch_scc0 L97
L97d:
  v_mov_b32 v5, 1
  s_mov_b64 exec, 1
  ds_add_u32 v0, v5 offset:124
  s_mov_b64 exec, -1
  s_lshl_b32 s73, s68, 14
  s_lshl_b32 s74, s64, 7
  s_add_u32 s80, s73, s74
  s_add_u32 s80, s80, 5242880
  v_and_b32 v5, 31, v1
  v_lshlrev_b32 v12, 2, v5
  v_and_b32 v6, 32, v1
  v_lshl_add_u32 v7, v6, 4, v12
  s_mul_i32 s73, s64, 3072
  v_add_u32 v8, s73, v7
  v_add_u32 v15, 128, v8
  v_and_b32 v5, 1, v3
  v_lshlrev_b32 v9, 3, v5
  v_lshl_add_u32 v9, v2, 4, v9
  v_lshrrev_b32 v6, 3, v6
  v_add_u32 v9, v9, v6
  v_lshlrev_b32 v10, 3, v2
  v_add_u32 v10, 156416, v10
  s_lshl_b32 s73, s64, 8
  s_add_u32 s73, s73, 156416
  v_lshl_add_u32 v11, v12, 1, s73
  s_mul_i32 s73, s68, 393216
  s_lshl_b32 s74, s90, 2
  s_add_u32 s74, s74, s64
  s_mul_i32 s74, s74, 768
  s_add_u32 s85, s73, s74
  s_add_u32 s85, s85, 7340032
  s_mov_b32 s79, 0x400000
L98:
  ds_read_b32 v5, v0 offset:72
  s_waitcnt lgkmcnt(0)
  v_cmp_gt_u32 vcc, 4, v5
  s_cbranch_vccz L99
  s_sleep 1
  s_sub_u32 s79, s79, 1
  s_cbranch_scc0 L98
L99:
  s_lshl_b32 s72, s67, 7
  s_add_u32 s72, s72, 8192
  s_mov_b32 s62, 1
  s_atomic_add s62, s[60:61], s72
  s_add_u32 s74, s86, 12288
  buffer_load_dwordx4 a[48:51], v4, s[48:51], s74 offen offset:0 sc1
  buffer_load_dwordx4 a[52:55], v4, s[48:51], s74 offen offset:1024 sc1
  buffer_load_dwordx4 a[56:59], v4, s[48:51], s74 offen offset:2048 sc1
  buffer_load_dwordx4 a[60:63], v4, s[48:51], s74 offen offset:3072 sc1
  s_add_u32 s74, s86, 16384
  buffer_load_dwordx4 a[64:67], v4, s[48:51], s74 offen offset:0 sc1
  buffer_load_dwordx4 a[68:71], v4, s[48:51], s74 offen offset:1024 sc1
  buffer_load_dwordx4 a[72:75], v4, s[48:51], s74 offen offset:2048 sc1
  buffer_load_dwordx4 a[76:79], v4, s[48:51], s74 offen offset:3072 sc1
  s_add_u32 s74, s86, 20480
  buffer_load_dwordx4 a[80:83], v4, s[48:51], s74 offen offset:0 sc1
  buffer_load_dwordx4 a[84:87], v4, s[48:51], s74 offen offset:1024 sc1
  buffer_load_dwordx4 a[88:91], v4, s[48:51], s74 offen offset:2048 sc1
  buffer_load_dwordx4 a[92:95], v4, s[48:51], s74 offen offset:3072 sc1
  s_mov_b32 s79, 131072
L100:
  s_mov_b32 s56, 0
  s_atomic_add s56, s[60:61], s75 glc
  s_waitcnt lgkmcnt(0)
  s_cmp_eq_u32 s56, 16
  s_cbranch_scc1 L100d
  s_sub_u32 s79, s79, 1
  s_cbranch_scc0 L100
L100d:
  v_mov_b32 v5, 1
  s_mov_b64 exec, 1
  ds_add_u32 v0, v5 offset:80
  s_mov_b64 exec, -1
Lh3:
  s_mov_b32 s79, 0x400000
L101:
  ds_read_b32 v5, v0 offset:80
  s_waitcnt lgkmcnt(0)
  v_cmp_gt_u32 vcc, 1, v5
  s_cbranch_vccz L102
  s_sleep 1
  s_sub_u32 s79, s79, 1
  s_cbranch_scc0 L101
L102:
  s_mov_b32 s79, 0x400000
L103:
  ds_read_b32 v5, v0 offset:84
  s_waitcnt lgkmcnt(0)
  v_cmp_gt_u32 vcc, 4, v5
  s_cbranch_vccz L104
  s_sleep 1
  s_sub_u32 s79, s79, 1
  s_cbranch_scc0 L103
L104:
  s_setprio 0
  s_add_u32 m0, s84, 65536
  s_add_u32 s75, s82, 32768
  buffer_load_dwordx4 v4, s[48:51], s75 offen offset:0 sc1 lds
  buffer_load_dwordx4 v4, s[48:51], s75 offen offset:1024 sc1 lds
  buffer_load_dwordx4 v4, s[48:51], s75 offen offset:2048 sc1 lds
  buffer_load_dwordx4 v4, s[48:51], s75 offen offset:3072 sc1 lds
  buffer_load_dword v60, v7, s[48:51], s80 offen offset:0 sc1
  buffer_load_dword v61, v7, s[48:51], s80 offen offset:1024 sc1
  buffer_load_dword v62, v7, s[48:51], s80 offen offset:2048 sc1
  buffer_load_dword v63, v7, s[48:51], s80 offen offset:3072 sc1
  s_add_u32 s80, s80, 4096
  buffer_load_dword v64, v7, s[48:51], s80 offen offset:0 sc1
  buffer_load_dword v65, v7, s[48:51], s80 offen offset:1024 sc1
  buffer_load_dword v66, v7, s[48:51], s80 offen offset:2048 sc1
  buffer_load_dword v67, v7, s[48:51], s80 offen offset:3072 sc1
  s_add_u32 s80, s80, 4096
  buffer_load_dword v68, v7, s[48:51], s80 offen offset:0 sc1
  buffer_load_dword v69, v7, s[48:51], s80 offen offset:1024 sc1
  buffer_load_dword v70, v7, s[48:51], s80 offen offset:2048 sc1
  buffer_load_dword v71, v7, s[48:51], s80 offen offset:3072 sc1
  s_add_u32 s80, s80, 4096
  buffer_load_dword v72, v7, s[48:51], s80 offen offset:0 sc1
  buffer_load_dword v73, v7, s[48:51], s80 offen offset:1024 sc1
  buffer_load_dword v74, v7, s[48:51], s80 offen offset:2048 sc1
  buffer_load_dword v75, v7, s[48:51], s80 offen offset:3072 sc1
  s_add_u32 m0, s84, 81920
  s_add_u32 s75, s82, 49152
  buffer_load_dwordx4 v4, s[48:51], s75 offen offset:0 sc1 lds
  buffer_load_dwordx4 v4, s[48:51], s75 offen offset:1024 sc1 lds
  buffer_load_dwordx4 v4, s[48:51], s75 offen offset:2048 sc1 lds
  buffer_load_dwordx4 v4, s[48:51], s75 offen offset:3072 sc1 lds
  s_mov_b32 s79, 0x400000
L105:
  ds_read_b32 v14, v0 offset:60
  s_waitcnt lgkmcnt(0)
  v_cmp_gt_u32 vcc, 4, v14
  s_cbranch_vccz L106
  s_sleep 1
  s_sub_u32 s79, s79, 1
  s_cbranch_scc0 L105
L106:
  ds_read2st64_b32 v[16:17], v8 offset0:48 offset1:49
  ds_read2st64_b32 v[22:23], v15 offset0:48 offset1:49
  ds_read2st64_b32 v[18:19], v8 offset0:52 offset1:53
  ds_read2st64_b32 v[24:25], v15 offset0:52 offset1:53
  ds_read2st64_b32 v[20:21], v8 offset0:56 offset1:57
  ds_read2st64_b32 v[26:27], v15 offset0:56 offset1:57
  s_mul_i32 s73, s64, 192
  s_add_u32 s73, s73, 157440
  v_mul_u32_u24 v13, 48, v3
  v_add_u32 v13, s73, v13
  s_waitcnt lgkmcnt(0)
  ds_write_b128 v13, v[16:19] offset:0
  ds_write_b128 v13, v[20:23] offset:16
  ds_write_b128 v13, v[24:27] offset:32
  s_waitcnt vmcnt(4)
  v_add_f32 v60, v60, v68
  v_add_f32 v61, v61, v69
  v_add_f32 v62, v62, v70
  v_add_f32 v63, v63, v71
  v_add_f32 v64, v64, v72
  v_add_f32 v65, v65, v73
  v_add_f32 v66, v66, v74
  v_add_f32 v67, v67, v75
  v_add_f32 v60, v60, v64
  v_add_f32 v61, v61, v65
  v_add_f32 v62, v62, v66
  v_add_f32 v63, v63, v67
  v_add_f32 v60, v60, v62
  v_add_f32 v61, v61, v63
  v_add_f32 v60, v60, v61
  v_mov_b32 v61, v60
  v_mov_b32 v62, 0x3727c5ac
  s_nop 0
  v_permlane32_swap_b32 v60, v61
  v_mul_f32 v60, 0xbb000000, v60
  v_fmamk_f32 v61, v61, 0x3b000000, v62
  v_fma_f32 v61, -v60, v60, v61
  v_max_f32 v61, v61, v62
  v_rcp_f32 v62, v61
  v_rsq_f32 v61, v61
  s_nop 0
  v_mul_f32 v61, 0xbfb8aa3b, v61
  ds_write_b64 v11, v[60:61]
  s_cmp_lg_u32 s90, 0
  s_cbranch_scc1 L107
  s_lshl_b32 s73, s91, 9
  s_lshl_b32 s76, s64, 7
  s_add_u32 s73, s73, s76
  s_add_u32 s73, s73, 5505024
  buffer_store_dword v62, v12, s[48:51], s73 offen sc1
L107:
  s_waitcnt lgkmcnt(0)
  s_barrier
  ds_read2st64_b32 v[28:29], v8 offset0:0 offset1:1
  ds_read2st64_b32 v[34:35], v15 offset0:0 offset1:1
  ds_read2st64_b32 v[30:31], v8 offset0:4 offset1:5
  ds_read2st64_b32 v[36:37], v15 offset0:4 offset1:5
  ds_read2st64_b32 v[32:33], v8 offset0:8 offset1:9
  ds_read2st64_b32 v[38:39], v15 offset0:8 offset1:9
  ds_read_b64 v[46:47], v10 offset:0
  s_add_u32 m0, s84, 98304
  s_add_u32 s75, s82, 65536
  buffer_load_dwordx4 v4, s[48:51], s75 offen offset:0 sc1 lds
  buffer_load_dwordx4 v4, s[48:51], s75 offen offset:1024 sc1 lds
  s_waitcnt lgkmcnt(0)
  v_fmac_f32 v28, v46, v16
  v_fmac_f32 v29, v46, v17
  v_fmac_f32 v30, v46, v18
  v_fmac_f32 v31, v46, v19
  v_fmac_f32 v32, v46, v20
  v_fmac_f32 v33, v46, v21
  v_mul_f32 v40, v28, v47
  v_mul_f32 v41, v29, v47
  buffer_load_dwordx4 v4, s[48:51], s75 offen offset:2048 sc1 lds
  v_mul_f32 v42, v30, v47
  v_mul_f32 v43, v31, v47
  v_mul_f32 v44, v32, v47
  v_mul_f32 v45, v33, v47
  v_exp_f32 v40, v40
  v_fmac_f32 v34, v46, v22
  v_exp_f32 v41, v41
  v_fmac_f32 v35, v46, v23
  buffer_load_dwordx4 v4, s[48:51], s75 offen offset:3072 sc1 lds
  v_exp_f32 v42, v42
  v_fmac_f32 v36, v46, v24
  v_exp_f32 v43, v43
  v_fmac_f32 v37, v46, v25
  v_exp_f32 v44, v44
  v_fmac_f32 v38, v46, v26
  v_exp_f32 v45, v45
  v_fmac_f32 v39, v46, v27
  s_add_u32 m0, s84, 114688
  s_add_u32 s75, s82, 81920
  buffer_load_dwordx4 v4, s[48:51], s75 offen offset:0 sc1 lds
  v_add_f32 v40, 1.0, v40
  v_add_f32 v41, 1.0, v41
  v_add_f32 v42, 1.0, v42
  v_add_f32 v43, 1.0, v43
  v_add_f32 v44, 1.0, v44
  v_add_f32 v45, 1.0, v45
  v_rcp_f32 v40, v40
  v_mul_f32 v28, v28, v34
  buffer_load_dwordx4 v4, s[48:51], s75 offen offset:1024 sc1 lds
  v_rcp_f32 v41, v41
  v_mul_f32 v29, v29, v35
  v_rcp_f32 v42, v42
  v_mul_f32 v30, v30, v36
  v_rcp_f32 v43, v43
  v_mul_f32 v31, v31, v37
  v_rcp_f32 v44, v44
  v_mul_f32 v32, v32, v38
  v_rcp_f32 v45, v45
  v_mul_f32 v33, v33, v39
  v_mul_f32 v40, v40, v28
  v_mul_f32 v41, v41, v29
  v_mul_f32 v42, v42, v30
  v_mul_f32 v43, v43, v31
  v_mul_f32 v44, v44, v32
  v_mul_f32 v45, v45, v33
  v_cvt_pk_bf16_f32 v48, v40, v41
  v_cvt_pk_bf16_f32 v49, v42, v43
  v_cvt_pk_bf16_f32 v50, v44, v45
  s_add_u32 s73, s85, 0
  buffer_store_dword v48, v9, s[48:51], s73 offen offset:0 sc1
  buffer_store_dword v49, v9, s[48:51], s73 offen offset:256 sc1
  buffer_store_dword v50, v9, s[48:51], s73 offen offset:512 sc1
  s_waitcnt lgkmcnt(0)
  s_waitcnt vmcnt(9)
  s_barrier
  ds_read2st64_b32 v[28:29], v8 offset0:48 offset1:49
  ds_read2st64_b32 v[34:35], v15 offset0:48 offset1:49
  ds_read2st64_b32 v[30:31], v8 offset0:52 offset1:53
  ds_read2st64_b32 v[36:37], v15 offset0:52 offset1:53
  ds_read2st64_b32 v[32:33], v8 offset0:56 offset1:57
  ds_read2st64_b32 v[38:39], v15 offset0:56 offset1:57
  ds_read_b64 v[46:47], v10 offset:128
  buffer_load_dwordx4 v4, s[48:51], s75 offen offset:2048 sc1 lds
  buffer_load_dwordx4 v4, s[48:51], s75 offen offset:3072 sc1 lds
  s_waitcnt lgkmcnt(0)
  v_fmac_f32 v28, v46, v16
  v_fmac_f32 v29, v46, v17
  v_fmac_f32 v30, v46, v18
  v_fmac_f32 v31, v46, v19
  v_fmac_f32 v32, v46, v20
  v_fmac_f32 v33, v46, v21
  v_mul_f32 v40, v28, v47
  v_mul_f32 v41, v29, v47
  s_add_u32 m0, s84, 0
  s_add_u32 s75, s82, 98304
  buffer_load_dwordx4 v4, s[48:51], s75 offen offset:0 sc1 lds
  v_mul_f32 v42, v30, v47
  v_mul_f32 v43, v31, v47
  v_mul_f32 v44, v32, v47
  v_mul_f32 v45, v33, v47
  v_exp_f32 v40, v40
  v_fmac_f32 v34, v46, v22
  v_exp_f32 v41, v41
  v_fmac_f32 v35, v46, v23
  buffer_load_dwordx4 v4, s[48:51], s75 offen offset:1024 sc1 lds
  v_exp_f32 v42, v42
  v_fmac_f32 v36, v46, v24
  v_exp_f32 v43, v43
  v_fmac_f32 v37, v46, v25
  v_exp_f32 v44, v44
  v_fmac_f32 v38, v46, v26
  v_exp_f32 v45, v45
  v_fmac_f32 v39, v46, v27
  buffer_load_dwordx4 v4, s[48:51], s75 offen offset:2048 sc1 lds
  v_add_f32 v40, 1.0, v40
  v_add_f32 v41, 1.0, v41
  v_add_f32 v42, 1.0, v42
  v_add_f32 v43, 1.0, v43
  v_add_f32 v44, 1.0, v44
  v_add_f32 v45, 1.0, v45
  v_rcp_f32 v40, v40
  v_mul_f32 v28, v28, v34
  buffer_load_dwordx4 v4, s[48:51], s75 offen offset:3072 sc1 lds
  v_rcp_f32 v41, v41
  v_mul_f32 v29, v29, v35
  v_rcp_f32 v42, v42
  v_mul_f32 v30, v30, v36
  v_rcp_f32 v43, v43
  v_mul_f32 v31, v31, v37
  v_rcp_f32 v44, v44
  v_mul_f32 v32, v32, v38
  v_rcp_f32 v45, v45
  v_mul_f32 v33, v33, v39
  v_mul_f32 v40, v40, v28
  v_mul_f32 v41, v41, v29
  v_mul_f32 v42, v42, v30
  v_mul_f32 v43, v43, v31
  v_mul_f32 v44, v44, v32
  v_mul_f32 v45, v45, v33
  v_cvt_pk_bf16_f32 v48, v40, v41
  v_cvt_pk_bf16_f32 v49, v42, v43
  v_cvt_pk_bf16_f32 v50, v44, v45
  s_add_u32 s73, s85, 49152
  buffer_store_dword v48, v9, s[48:51], s73 offen offset:0 sc1
  buffer_store_dword v49, v9, s[48:51], s73 offen offset:256 sc1
  buffer_store_dword v50, v9, s[48:51], s73 offen offset:512 sc1
  s_waitcnt lgkmcnt(0)
  s_waitcnt vmcnt(14)
  s_barrier
  ds_read2st64_b32 v[28:29], v8 offset0:0 offset1:1
  ds_read2st64_b32 v[34:35], v15 offset0:0 offset1:1
  ds_read2st64_b32 v[30:31], v8 offset0:4 offset1:5
  ds_read2st64_b32 v[36:37], v15 offset0:4 offset1:5
  ds_read2st64_b32 v[32:33], v8 offset0:8 offset1:9
  ds_read2st64_b32 v[38:39], v15 offset0:8 offset1:9
  ds_read_b64 v[46:47], v10 offset:256
  s_add_u32 m0, s84, 16384
  s_add_u32 s75, s82, 114688
  buffer_load_dwordx4 v4, s[48:51], s75 offen offset:0 sc1 lds
  buffer_load_dwordx4 v4, s[48:51], s75 offen offset:1024 sc1 lds
  s_waitcnt lgkmcnt(0)
  v_fmac_f32 v28, v46, v16
  v_fmac_f32 v29, v46, v17
  v_fmac_f32 v30, v46, v18
  v_fmac_f32 v31, v46, v19
  v_fmac_f32 v32, v46, v20
  v_fmac_f32 v33, v46, v21
  v_mul_f32 v40, v28, v47
  v_mul_f32 v41, v29, v47
  buffer_load_dwordx4 v4, s[48:51], s75 offen offset:2048 sc1 lds
  v_mul_f32 v42, v30, v47
  v_mul_f32 v43, v31, v47
  v_mul_f32 v44, v32, v47
  v_mul_f32 v45, v33, v47
  v_exp_f32 v40, v40
  v_fmac_f32 v34, v46, v22
  v_exp_f32 v41, v41
  v_fmac_f32 v35, v46, v23
  buffer_load_dwordx4 v4, s[48:51], s75 offen offset:3072 sc1 lds
  v_exp_f32 v42, v42
  v_fmac_f32 v36, v46, v24
  v_exp_f32 v43, v43
  v_fmac_f32 v37, v46, v25
  v_exp_f32 v44, v44
  v_fmac_f32 v38, v46, v26
  v_exp_f32 v45, v45
  v_fmac_f32 v39, v46, v27
  s_add_u32 s74, s86, 24576
  buffer_load_dwordx4 a[96:99], v4, s[48:51], s74 offen offset:0 sc1
  v_add_f32 v40, 1.0, v40
  v_add_f32 v41, 1.0, v41
  v_add_f32 v42, 1.0, v42
  v_add_f32 v43, 1.0, v43
  v_add_f32 v44, 1.0, v44
  v_add_f32 v45, 1.0, v45
  v_rcp_f32 v40, v40
  v_mul_f32 v28, v28, v34
  buffer_load_dwordx4 a[100:103], v4, s[48:51], s74 offen offset:1024 sc1
  v_rcp_f32 v41, v41
  v_mul_f32 v29, v29, v35
  v_rcp_f32 v42, v42
  v_mul_f32 v30, v30, v36
  v_rcp_f32 v43, v43
  v_mul_f32 v31, v31, v37
  v_rcp_f32 v44, v44
  v_mul_f32 v32, v32, v38
  v_rcp_f32 v45, v45
  v_mul_f32 v33, v33, v39
  v_mul_f32 v40, v40, v28
  v_mul_f32 v41, v41, v29
  v_mul_f32 v42, v42, v30
  v_mul_f32 v43, v43, v31
  v_mul_f32 v44, v44, v32
  v_mul_f32 v45, v45, v33
  v_cvt_pk_bf16_f32 v48, v40, v41
  v_cvt_pk_bf16_f32 v49, v42, v43
  v_cvt_pk_bf16_f32 v50, v44, v45
  s_add_u32 s73, s85, 98304
  buffer_store_dword v48, v9, s[48:51], s73 offen offset:0 sc1
  buffer_store_dword v49, v9, s[48:51], s73 offen offset:256 sc1
  buffer_store_dword v50, v9, s[48:51], s73 offen offset:512 sc1
  s_waitcnt lgkmcnt(0)
  s_waitcnt vmcnt(16)
  s_barrier
  ds_read2st64_b32 v[28:29], v8 offset0:48 offset1:49
  ds_read2st64_b32 v[34:35], v15 offset0:48 offset1:49
  ds_read2st64_b32 v[30:31], v8 offset0:52 offset1:53
  ds_read2st64_b32 v[36:37], v15 offset0:52 offset1:53
  ds_read2st64_b32 v[32:33], v8 offset0:56 offset1:57
  ds_read2st64_b32 v[38:39], v15 offset0:56 offset1:57
  ds_read_b64 v[46:47], v10 offset:384
  buffer_load_dwordx4 a[104:107], v4, s[48:51], s74 offen offset:2048 sc1
  buffer_load_dwordx4 a[108:111], v4, s[48:51], s74 offen offset:3072 sc1
  s_waitcnt lgkmcnt(0)
  v_fmac_f32 v28, v46, v16
  v_fmac_f32 v29, v46, v17
  v_fmac_f32 v30, v46, v18
  v_fmac_f32 v31, v46, v19
  v_fmac_f32 v32, v46, v20
  v_fmac_f32 v33, v46, v21
  v_mul_f32 v40, v28, v47
  v_mul_f32 v41, v29, v47
  s_add_u32 s74, s86, 28672
  buffer_load_dwordx4 a[112:115], v4, s[48:51], s74 offen offset:0 sc1
  v_mul_f32 v42, v30, v47
  v_mul_f32 v43, v31, v47
  v_mul_f32 v44, v32, v47
  v_mul_f32 v45, v33, v47
  v_exp_f32 v40, v40
  v_fmac_f32 v34, v46, v22
  v_exp_f32 v41, v41
  v_fmac_f32 v35, v46, v23
  buffer_load_dwordx4 a[116:119], v4, s[48:51], s74 offen offset:1024 sc1
  v_exp_f32 v42, v42
  v_fmac_f32 v36, v46, v24
  v_exp_f32 v43, v43
  v_fmac_f32 v37, v46, v25
  v_exp_f32 v44, v44
  v_fmac_f32 v38, v46, v26
  v_exp_f32 v45, v45
  v_fmac_f32 v39, v46, v27
  buffer_load_dwordx4 a[120:123], v4, s[48:51], s74 offen offset:2048 sc1
  v_add_f32 v40, 1.0, v40
  v_add_f32 v41, 1.0, v41
  v_add_f32 v42, 1.0, v42
  v_add_f32 v43, 1.0, v43
  v_add_f32 v44, 1.0, v44
  v_add_f32 v45, 1.0, v45
  v_rcp_f32 v40, v40
  v_mul_f32 v28, v28, v34
  buffer_load_dwordx4 a[124:127], v4, s[48:51], s74 offen offset:3072 sc1
  v_rcp_f32 v41, v41
  v_mul_f32 v29, v29, v35
  v_rcp_f32 v42, v42
  v_mul_f32 v30, v30, v36
  v_rcp_f32 v43, v43
  v_mul_f32 v31, v31, v37
  v_rcp_f32 v44, v44
  v_mul_f32 v32, v32, v38
  v_rcp_f32 v45, v45
  v_mul_f32 v33, v33, v39
  v_mul_f32 v40, v40, v28
  v_mul_f32 v41, v41, v29
  v_mul_f32 v42, v42, v30
  v_mul_f32 v43, v43, v31
  v_mul_f32 v44, v44, v32
  v_mul_f32 v45, v45, v33
  v_cvt_pk_bf16_f32 v48, v40, v41
  v_cvt_pk_bf16_f32 v49, v42, v43
  v_cvt_pk_bf16_f32 v50, v44, v45
  s_add_u32 s73, s85, 147456
  buffer_store_dword v48, v9, s[48:51], s73 offen offset:0 sc1
  buffer_store_dword v49, v9, s[48:51], s73 offen offset:256 sc1
  buffer_store_dword v50, v9, s[48:51], s73 offen offset:512 sc1
  s_waitcnt lgkmcnt(0)
  s_waitcnt vmcnt(21)
  s_barrier
  ds_read2st64_b32 v[28:29], v8 offset0:0 offset1:1
  ds_read2st64_b32 v[34:35], v15 offset0:0 offset1:1
  ds_read2st64_b32 v[30:31], v8 offset0:4 offset1:5
  ds_read2st64_b32 v[36:37], v15 offset0:4 offset1:5
  ds_read2st64_b32 v[32:33], v8 offset0:8 offset1:9
  ds_read2st64_b32 v[38:39], v15 offset0:8 offset1:9
  ds_read_b64 v[46:47], v10 offset:512
  s_add_u32 s74, s86, 32768
  buffer_load_dwordx4 v[80:83], v4, s[48:51], s74 offen offset:0 sc1
  buffer_load_dwordx4 v[84:87], v4, s[48:51], s74 offen offset:1024 sc1
  s_waitcnt lgkmcnt(0)
  v_fmac_f32 v28, v46, v16
  v_fmac_f32 v29, v46, v17
  v_fmac_f32 v30, v46, v18
  v_fmac_f32 v31, v46, v19
  v_fmac_f32 v32, v46, v20
  v_fmac_f32 v33, v46, v21
  v_mul_f32 v40, v28, v47
  v_mul_f32 v41, v29, v47
  buffer_load_dwordx4 v[88:91], v4, s[48:51], s74 offen offset:2048 sc1
  v_mul_f32 v42, v30, v47
  v_mul_f32 v43, v31, v47
  v_mul_f32 v44, v32, v47
  v_mul_f32 v45, v33, v47
  v_exp_f32 v40, v40
  v_fmac_f32 v34, v46, v22
  v_exp_f32 v41, v41
  v_fmac_f32 v35, v46, v23
  buffer_load_dwordx4 v[92:95], v4, s[48:51], s74 offen offset:3072 sc1
  v_exp_f32 v42, v42
  v_fmac_f32 v36, v46, v24
  v_exp_f32 v43, v43
  v_fmac_f32 v37, v46, v25
  v_exp_f32 v44, v44
  v_fmac_f32 v38, v46, v26
  v_exp_f32 v45, v45
  v_fmac_f32 v39, v46, v27
  s_add_u32 s74, s86, 36864
  buffer_load_dwordx4 v[96:99], v4, s[48:51], s74 offen offset:0 sc1
  v_add_f32 v40, 1.0, v40
  v_add_f32 v41, 1.0, v41
  v_add_f32 v42, 1.0, v42
  v_add_f32 v43, 1.0, v43
  v_add_f32 v44, 1.0, v44
  v_add_f32 v45, 1.0, v45
  v_rcp_f32 v40, v40
  v_mul_f32 v28, v28, v34
  buffer_load_dwordx4 v[100:103], v4, s[48:51], s74 offen offset:1024 sc1
  v_rcp_f32 v41, v41
  v_mul_f32 v29, v29, v35
  v_rcp_f32 v42, v42
  v_mul_f32 v30, v30, v36
  v_rcp_f32 v43, v43
  v_mul_f32 v31, v31, v37
  v_rcp_f32 v44, v44
  v_mul_f32 v32, v32, v38
  v_rcp_f32 v45, v45
  v_mul_f32 v33, v33, v39
  v_mul_f32 v40, v40, v28
  v_mul_f32 v41, v41, v29
  v_mul_f32 v42, v42, v30
  v_mul_f32 v43, v43, v31
  v_mul_f32 v44, v44, v32
  v_mul_f32 v45, v45, v33
  v_cvt_pk_bf16_f32 v48, v40, v41
  v_cvt_pk_bf16_f32 v49, v42, v43
  v_cvt_pk_bf16_f32 v50, v44, v45
  s_add_u32 s73, s85, 196608
  buffer_store_dword v48, v9, s[48:51], s73 offen offset:0 sc1
  buffer_store_dword v49, v9, s[48:51], s73 offen offset:256 sc1
  buffer_store_dword v50, v9, s[48:51], s73 offen offset:512 sc1
  s_waitcnt lgkmcnt(0)
  s_waitcnt vmcnt(23)
  s_waitcnt vmcnt(9)
  s_barrier
  s_cmp_lg_u32 s64, 0
  s_cbranch_scc1 L108
  s_lshl_b32 s72, s91, 7
  s_add_u32 s72, s72, 14336
  v_mov_b32 v5, 1
  v_mov_b32 v6, 0
  s_mov_b64 exec, 1
  buffer_atomic_add v5, v6, s[48:51], s72 offen
  s_mov_b64 exec, -1
L108:
  ds_read2st64_b32 v[28:29], v8 offset0:48 offset1:49
  ds_read2st64_b32 v[34:35], v15 offset0:48 offset1:49
  ds_read2st64_b32 v[30:31], v8 offset0:52 offset1:53
  ds_read2st64_b32 v[36:37], v15 offset0:52 offset1:53
  ds_read2st64_b32 v[32:33], v8 offset0:56 offset1:57
  ds_read2st64_b32 v[38:39], v15 offset0:56 offset1:57
  ds_read_b64 v[46:47], v10 offset:640
  buffer_load_dwordx4 v[104:107], v4, s[48:51], s74 offen offset:2048 sc1
  buffer_load_dwordx4 v[108:111], v4, s[48:51], s74 offen offset:3072 sc1
  s_waitcnt lgkmcnt(0)
  v_fmac_f32 v28, v46, v16
  v_fmac_f32 v29, v46, v17
  v_fmac_f32 v30, v46, v18
  v_fmac_f32 v31, v46, v19
  v_fmac_f32 v32, v46, v20
  v_fmac_f32 v33, v46, v21
  v_mul_f32 v40, v28, v47
  v_mul_f32 v41, v29, v47
  s_add_u32 s74, s86, 40960
  buffer_load_dwordx4 v[112:115], v4, s[48:51], s74 offen offset:0 sc1
  v_mul_f32 v42, v30, v47
  v_mul_f32 v43, v31, v47
  v_mul_f32 v44, v32, v47
  v_mul_f32 v45, v33, v47
  v_exp_f32 v40, v40
  v_fmac_f32 v34, v46, v22
  v_exp_f32 v41, v41
  v_fmac_f32 v35, v46, v23
  buffer_load_dwordx4 v[116:119], v4, s[48:51], s74 offen offset:1024 sc1
  v_exp_f32 v42, v42
  v_fmac_f32 v36, v46, v24
  v_exp_f32 v43, v43
  v_fmac_f32 v37, v46, v25
  v_exp_f32 v44, v44
  v_fmac_f32 v38, v46, v26
  v_exp_f32 v45, v45
  v_fmac_f32 v39, v46, v27
  buffer_load_dwordx4 v[120:123], v4, s[48:51], s74 offen offset:2048 sc1
  v_add_f32 v40, 1.0, v40
  v_add_f32 v41, 1.0, v41
  v_add_f32 v42, 1.0, v42
  v_add_f32 v43, 1.0, v43
  v_add_f32 v44, 1.0, v44
  v_add_f32 v45, 1.0, v45
  v_rcp_f32 v40, v40
  v_mul_f32 v28, v28, v34
  buffer_load_dwordx4 v[124:127], v4, s[48:51], s74 offen offset:3072 sc1
  v_rcp_f32 v41, v41
  v_mul_f32 v29, v29, v35
  v_rcp_f32 v42, v42
  v_mul_f32 v30, v30, v36
  v_rcp_f32 v43, v43
  v_mul_f32 v31, v31, v37
  v_rcp_f32 v44, v44
  v_mul_f32 v32, v32, v38
  v_rcp_f32 v45, v45
  v_mul_f32 v33, v33, v39
  v_mul_f32 v40, v40, v28
  v_mul_f32 v41, v41, v29
  v_mul_f32 v42, v42, v30
  v_mul_f32 v43, v43, v31
  v_mul_f32 v44, v44, v32
  v_mul_f32 v45, v45, v33
  v_cvt_pk_bf16_f32 v48, v40, v41
  v_cvt_pk_bf16_f32 v49, v42, v43
  v_cvt_pk_bf16_f32 v50, v44, v45
  s_add_u32 s73, s85, 245760
  buffer_store_dword v48, v9, s[48:51], s73 offen offset:0 sc1
  buffer_store_dword v49, v9, s[48:51], s73 offen offset:256 sc1
  buffer_store_dword v50, v9, s[48:51], s73 offen offset:512 sc1
  s_waitcnt lgkmcnt(0)
  s_barrier
  ds_read2st64_b32 v[28:29], v8 offset0:0 offset1:1
  ds_read2st64_b32 v[34:35], v15 offset0:0 offset1:1
  ds_read2st64_b32 v[30:31], v8 offset0:4 offset1:5
  ds_read2st64_b32 v[36:37], v15 offset0:4 offset1:5
  ds_read2st64_b32 v[32:33], v8 offset0:8 offset1:9
  ds_read2st64_b32 v[38:39], v15 offset0:8 offset1:9
  ds_read_b64 v[46:47], v10 offset:768
  s_waitcnt lgkmcnt(0)
  v_fmac_f32 v28, v46, v16
  v_fmac_f32 v29, v46, v17
  v_fmac_f32 v30, v46, v18
  v_fmac_f32 v31, v46, v19
  v_fmac_f32 v32, v46, v20
  v_fmac_f32 v33, v46, v21
  v_mul_f32 v40, v28, v47
  v_mul_f32 v41, v29, v47
  v_mul_f32 v42, v30, v47
  v_mul_f32 v43, v31, v47
  v_mul_f32 v44, v32, v47
  v_mul_f32 v45, v33, v47
  v_exp_f32 v40, v40
  v_fmac_f32 v34, v46, v22
  v_exp_f32 v41, v41
  v_fmac_f32 v35, v46, v23
  v_exp_f32 v42, v42
  v_fmac_f32 v36, v46, v24
  v_exp_f32 v43, v43
  v_fmac_f32 v37, v46, v25
  v_exp_f32 v44, v44
  v_fmac_f32 v38, v46, v26
  v_exp_f32 v45, v45
  v_fmac_f32 v39, v46, v27
  v_add_f32 v40, 1.0, v40
  v_add_f32 v41, 1.0, v41
  v_add_f32 v42, 1.0, v42
  v_add_f32 v43, 1.0, v43
  v_add_f32 v44, 1.0, v44
  v_add_f32 v45, 1.0, v45
  v_rcp_f32 v40, v40
  v_mul_f32 v28, v28, v34
  v_rcp_f32 v41, v41
  v_mul_f32 v29, v29, v35
  v_rcp_f32 v42, v42
  v_mul_f32 v30, v30, v36
  v_rcp_f32 v43, v43
  v_mul_f32 v31, v31, v37
  v_rcp_f32 v44, v44
  v_mul_f32 v32, v32, v38
  v_rcp_f32 v45, v45
  v_mul_f32 v33, v33, v39
  v_mul_f32 v40, v40, v28
  v_mul_f32 v41, v41, v29
  v_mul_f32 v42, v42, v30
  v_mul_f32 v43, v43, v31
  v_mul_f32 v44, v44, v32
  v_mul_f32 v45, v45, v33
  v_cvt_pk_bf16_f32 v48, v40, v41
  v_cvt_pk_bf16_f32 v49, v42, v43
  v_cvt_pk_bf16_f32 v50, v44, v45
  s_add_u32 s73, s85, 294912
  buffer_store_dword v48, v9, s[48:51], s73 offen offset:0 sc1
  buffer_store_dword v49, v9, s[48:51], s73 offen offset:256 sc1
  buffer_store_dword v50, v9, s[48:51], s73 offen offset:512 sc1
  s_setprio 1
  s_waitcnt vmcnt(3)
  v_mov_b32 v5, 1
  s_mov_b64 exec, 1
  ds_add_rtn_u32 v5, v0, v5 offset:44
  s_waitcnt lgkmcnt(0)
  v_cmp_eq_u32 vcc, 3, v5
  s_mov_b64 exec, -1
  s_cbranch_vccz L109
  s_lshl_b32 s72, s91, 7
  s_add_u32 s72, s72, 12288
  s_mov_b32 s62, 1
  s_atomic_add s62, s[60:61], s72
L109:
  s_mul_i32 s72, s67, 393216
  s_mul_i32 s73, s71, 49152
  s_add_u32 s72, s72, s73
  s_mul_i32 s73, s64, 11264
  s_add_u32 s72, s72, s73
  s_add_u32 s80, s72, 7340032
  s_add_u32 s81, s72, 7438336
  s_add_u32 s82, s72, 7536640
  s_add_u32 s83, s72, 7634944
  s_mul_i32 s73, s64, 4224
  s_add_u32 s73, s73, 24576
  v_mul_u32_u24 v7, 264, v2
  v_lshl_add_u32 v7, v3, 6, v7
  v_add_u32 v7, s73, v7
  v_add_u32 v1, 4096, v4
  v_add_u32 v2, 8192, v4
  s_mov_b32 s79, 0x400000
L110:
  ds_read_b32 v5, v0 offset:40
  s_waitcnt lgkmcnt(0)
  v_cmp_gt_u32 vcc, 4, v5
  s_cbranch_vccz L111
  s_sleep 1
  s_sub_u32 s79, s79, 1
  s_cbranch_scc0 L110
L111:
  ds_read_b32 v6, v0 offset:96
  s_waitcnt lgkmcnt(0)
  v_readfirstlane_b32 s63, v6
  s_nop 0
  s_cmp_eq_u32 s63, 0
  s_cbranch_scc1 L112
  buffer_load_dwordx4 v[40:43], v4, s[48:51], s80 offen offset:0 sc1
  buffer_load_dwordx4 v[44:47], v4, s[48:51], s80 offen offset:1024 sc1
  buffer_load_dwordx4 v[48:51], v4, s[48:51], s80 offen offset:2048 sc1
  buffer_load_dwordx4 v[52:55], v4, s[48:51], s80 offen offset:3072 sc1
  buffer_load_dwordx4 v[56:59], v1, s[48:51], s80 offen offset:0 sc1
  buffer_load_dwordx4 v[60:63], v1, s[48:51], s80 offen offset:1024 sc1
  buffer_load_dwordx4 v[64:67], v1, s[48:51], s80 offen offset:2048 sc1
  buffer_load_dwordx4 v[68:71], v1, s[48:51], s80 offen offset:3072 sc1
  buffer_load_dwordx4 v[72:75], v2, s[48:51], s80 offen offset:0 sc1
  buffer_load_dwordx4 v[76:79], v2, s[48:51], s80 offen offset:1024 sc1
  s_waitcnt vmcnt(10)
  v_mov_b32 v5, 1
  s_mov_b64 exec, 1
  ds_add_rtn_u32 v5, v0, v5 offset:92
  s_waitcnt lgkmcnt(0)
  v_cmp_eq_u32 vcc, 7, v5
  s_mov_b64 exec, -1
  s_cbranch_vccz L114
  s_lshl_b32 s72, s91, 7
  s_add_u32 s72, s72, 10240
  s_mov_b32 s62, 1
  s_atomic_add s62, s[60:61], s72
L114:
  s_branch L113
L112:
  s_waitcnt vmcnt(0)
  v_mov_b32 v5, 1
  s_mov_b64 exec, 1
  ds_add_rtn_u32 v5, v0, v5 offset:92
  s_waitcnt lgkmcnt(0)
  v_cmp_eq_u32 vcc, 7, v5
  s_mov_b64 exec, -1
  s_cbranch_vccz L115
  s_lshl_b32 s72, s91, 7
  s_add_u32 s72, s72, 10240
  s_mov_b32 s62, 1
  s_atomic_add s62, s[60:61], s72
L115:
  s_mov_b32 s79, 0x400000
L116:
  ds_read_b32 v5, v0 offset:96
  s_waitcnt lgkmcnt(0)
  v_cmp_gt_u32 vcc, 1, v5
  s_cbranch_vccz L117
  s_sleep 1
  s_sub_u32 s79, s79, 1
  s_cbranch_scc0 L116
L117:
  buffer_load_dwordx4 v[40:43], v4, s[48:51], s80 offen offset:0 sc1
  buffer_load_dwordx4 v[44:47], v4, s[48:51], s80 offen offset:1024 sc1
  buffer_load_dwordx4 v[48:51], v4, s[48:51], s80 offen offset:2048 sc1
  buffer_load_dwordx4 v[52:55], v4, s[48:51], s80 offen offset:3072 sc1
  buffer_load_dwordx4 v[56:59], v1, s[48:51], s80 offen offset:0 sc1
  buffer_load_dwordx4 v[60:63], v1, s[48:51], s80 offen offset:1024 sc1
  buffer_load_dwordx4 v[64:67], v1, s[48:51], s80 offen offset:2048 sc1
  buffer_load_dwordx4 v[68:71], v1, s[48:51], s80 offen offset:3072 sc1
  buffer_load_dwordx4 v[72:75], v2, s[48:51], s80 offen offset:0 sc1
  buffer_load_dwordx4 v[76:79], v2, s[48:51], s80 offen offset:1024 sc1
L113:
  s_waitcnt vmcnt(9)
  v_mfma_f32_16x16x32_bf16 v[8:11], a[0:3], v[40:43], 0
  v_mfma_f32_16x16x32_bf16 v[12:15], a[4:7], v[40:43], 0
  v_mfma_f32_16x16x32_bf16 v[16:19], a[8:11], v[40:43], 0
  v_mfma_f32_16x16x32_bf16 v[20:23], a[12:15], v[40:43], 0
  buffer_load_dwordx4 v[40:43], v2, s[48:51], s80 offen offset:2048 sc1
  s_waitcnt vmcnt(9)
  v_mfma_f32_16x16x32_bf16 v[8:11], a[16:19], v[44:47], v[8:11]
  v_mfma_f32_16x16x32_bf16 v[12:15], a[20:23], v[44:47], v[12:15]
  v_mfma_f32_16x16x32_bf16 v[16:19], a[24:27], v[44:47], v[16:19]
  v_mfma_f32_16x16x32_bf16 v[20:23], a[28:31], v[44:47], v[20:23]
  buffer_load_dwordx4 v[44:47], v4, s[48:51], s81 offen offset:0 sc1
  s_waitcnt vmcnt(9)
  v_mfma_f32_16x16x32_bf16 v[8:11], a[32:35], v[48:51], v[8:11]
  v_mfma_f32_16x16x32_bf16 v[12:15], a[36:39], v[48:51], v[12:15]
  v_mfma_f32_16x16x32_bf16 v[16:19], a[40:43], v[48:51], v[16:19]
  v_mfma_f32_16x16x32_bf16 v[20:23], a[44:47], v[48:51], v[20:23]
  buffer_load_dwordx4 v[48:51], v4, s[48:51], s81 offen offset:1024 sc1
  s_waitcnt vmcnt(9)
  v_mfma_f32_16x16x32_bf16 v[8:11], a[48:51], v[52:55], v[8:11]
  v_mfma_f32_16x16x32_bf16 v[12:15], a[52:55], v[52:55], v[12:15]
  v_mfma_f32_16x16x32_bf16 v[16:19], a[56:59], v[52:55], v[16:19]
  v_mfma_f32_16x16x32_bf16 v[20:23], a[60:63], v[52:55], v[20:23]
  buffer_load_dwordx4 v[52:55], v4, s[48:51], s81 offen offset:2048 sc1
  s_waitcnt vmcnt(9)
  v_mfma_f32_16x16x32_bf16 v[8:11], a[64:67], v[56:59], v[8:11]
  v_mfma_f32_16x16x32_bf16 v[12:15], a[68:71], v[56:59], v[12:15]
  v_mfma_f32_16x16x32_bf16 v[16:19], a[72:75], v[56:59], v[16:19]
  v_mfma_f32_16x16x32_bf16 v[20:23], a[76:79], v[56:59], v[20:23]
  buffer_load_dwordx4 v[56:59], v4, s[48:51], s81 offen offset:3072 sc1
  s_waitcnt vmcnt(9)
  v_mfma_f32_16x16x32_bf16 v[8:11], a[80:83], v[60:63], v[8:11]
  v_mfma_f32_16x16x32_bf16 v[12:15], a[84:87], v[60:63], v[12:15]
  v_mfma_f32_16x16x32_bf16 v[16:19], a[88:91], v[60:63], v[16:19]
  v_mfma_f32_16x16x32_bf16 v[20:23], a[92:95], v[60:63], v[20:23]
  buffer_load_dwordx4 v[60:63], v1, s[48:51], s81 offen offset:0 sc1
  s_waitcnt vmcnt(9)
  v_mfma_f32_16x16x32_bf16 v[8:11], a[96:99], v[64:67], v[8:11]
  v_mfma_f32_16x16x32_bf16 v[12:15], a[100:103], v[64:67], v[12:15]
  v_mfma_f32_16x16x32_bf16 v[16:19], a[104:107], v[64:67], v[16:19]
  v_mfma_f32_16x16x32_bf16 v[20:23], a[108:111], v[64:67], v[20:23]
  buffer_load_dwordx4 v[64:67], v1, s[48:51], s81 offen offset:1024 sc1
  s_waitcnt vmcnt(9)
  v_mfma_f32_16x16x32_bf16 v[8:11], a[112:115], v[68:71], v[8:11]
  v_mfma_f32_16x16x32_bf16 v[12:15], a[116:119], v[68:71], v[12:15]
  v_mfma_f32_16x16x32_bf16 v[16:19], a[120:123], v[68:71], v[16:19]
  v_mfma_f32_16x16x32_bf16 v[20:23], a[124:127], v[68:71], v[20:23]
  buffer_load_dwordx4 v[68:71], v1, s[48:51], s81 offen offset:2048 sc1
  s_waitcnt vmcnt(9)
  v_mfma_f32_16x16x32_bf16 v[8:11], v[80:83], v[72:75], v[8:11]
  v_mfma_f32_16x16x32_bf16 v[12:15], v[84:87], v[72:75], v[12:15]
  v_mfma_f32_16x16x32_bf16 v[16:19], v[88:91], v[72:75], v[16:19]
  v_mfma_f32_16x16x32_bf16 v[20:23], v[92:95], v[72:75], v[20:23]
  buffer_load_dwordx4 v[72:75], v1, s[48:51], s81 offen offset:3072 sc1
  s_waitcnt vmcnt(9)
  v_mfma_f32_16x16x32_bf16 v[8:11], v[96:99], v[76:79], v[8:11]
  v_mfma_f32_16x16x32_bf16 v[12:15], v[100:103], v[76:79], v[12:15]
  v_mfma_f32_16x16x32_bf16 v[16:19], v[104:107], v[76:79], v[16:19]
  v_mfma_f32_16x16x32_bf16 v[20:23], v[108:111], v[76:79], v[20:23]
  buffer_load_dwordx4 v[76:79], v2, s[48:51], s81 offen offset:0 sc1
  s_waitcnt vmcnt(9)
  s_cmp_eq_u32 s64, 3
  s_cbranch_scc1 L118
  v_mfma_f32_16x16x32_bf16 v[8:11], v[112:115], v[40:43], v[8:11]
  v_mfma_f32_16x16x32_bf16 v[12:15], v[116:119], v[40:43], v[12:15]
  v_mfma_f32_16x16x32_bf16 v[16:19], v[120:123], v[40:43], v[16:19]
  v_mfma_f32_16x16x32_bf16 v[20:23], v[124:127], v[40:43], v[20:23]
L118:
  buffer_load_dwordx4 v[40:43], v2, s[48:51], s81 offen offset:1024 sc1
  s_waitcnt vmcnt(9)
  v_mfma_f32_16x16x32_bf16 v[24:27], a[0:3], v[44:47], 0
  v_mfma_f32_16x16x32_bf16 v[28:31], a[4:7], v[44:47], 0
  v_mfma_f32_16x16x32_bf16 v[32:35], a[8:11], v[44:47], 0
  v_mfma_f32_16x16x32_bf16 v[36:39], a[12:15], v[44:47], 0
  buffer_load_dwordx4 v[44:47], v2, s[48:51], s81 offen offset:2048 sc1
  s_waitcnt vmcnt(9)
  v_mfma_f32_16x16x32_bf16 v[24:27], a[16:19], v[48:51], v[24:27]
  v_mfma_f32_16x16x32_bf16 v[28:31], a[20:23], v[48:51], v[28:31]
  v_mfma_f32_16x16x32_bf16 v[32:35], a[24:27], v[48:51], v[32:35]
  v_mfma_f32_16x16x32_bf16 v[36:39], a[28:31], v[48:51], v[36:39]
  s_mov_b32 s79, 0x400000
L119:
  ds_read_b32 v5, v0 offset:100
  s_waitcnt lgkmcnt(0)
  v_cmp_gt_u32 vcc, 1, v5
  s_cbranch_vccz L120
  s_sleep 1
  s_sub_u32 s79, s79, 1
  s_cbranch_scc0 L119
L120:
  buffer_load_dwordx4 v[48:51], v4, s[48:51], s82 offen offset:0 sc1
  s_waitcnt vmcnt(9)
  v_mfma_f32_16x16x32_bf16 v[24:27], a[32:35], v[52:55], v[24:27]
  ds_write_b32 v7, v8 offset:0
  v_mfma_f32_16x16x32_bf16 v[28:31], a[36:39], v[52:55], v[28:31]
  ds_write_b32 v7, v9 offset:16
  v_mfma_f32_16x16x32_bf16 v[32:35], a[40:43], v[52:55], v[32:35]
  ds_write_b32 v7, v10 offset:32
  v_mfma_f32_16x16x32_bf16 v[36:39], a[44:47], v[52:55], v[36:39]
  ds_write_b32 v7, v11 offset:48
  buffer_load_dwordx4 v[52:55], v4, s[48:51], s82 offen offset:1024 sc1
  s_waitcnt vmcnt(9)
  v_mfma_f32_16x16x32_bf16 v[24:27], a[48:51], v[56:59], v[24:27]
  ds_write_b32 v7, v12 offset:4
  v_mfma_f32_16x16x32_bf16 v[28:31], a[52:55], v[56:59], v[28:31]
  ds_write_b32 v7, v13 offset:20
  v_mfma_f32_16x16x32_bf16 v[32:35], a[56:59], v[56:59], v[32:35]
  ds_write_b32 v7, v14 offset:36
  v_mfma_f32_16x16x32_bf16 v[36:39], a[60:63], v[56:59], v[36:39]
  ds_write_b32 v7, v15 offset:52
  buffer_load_dwordx4 v[56:59], v4, s[48:51], s82 offen offset:2048 sc1
  s_waitcnt vmcnt(9)
  v_mfma_f32_16x16x32_bf16 v[24:27], a[64:67], v[60:63], v[24:27]
  ds_write_b32 v7, v16 offset:8
  v_mfma_f32_16x16x32_bf16 v[28:31], a[68:71], v[60:63], v[28:31]
  ds_write_b32 v7, v17 offset:24
  v_mfma_f32_16x16x32_bf16 v[32:35], a[72:75], v[60:63], v[32:35]
  ds_write_b32 v7, v18 offset:40
  v_mfma_f32_16x16x32_bf16 v[36:39], a[76:79], v[60:63], v[36:39]
  ds_write_b32 v7, v19 offset:56
  buffer_load_dwordx4 v[60:63], v4, s[48:51], s82 offen offset:3072 sc1
  s_waitcnt vmcnt(9)
  v_mfma_f32_16x16x32_bf16 v[24:27], a[80:83], v[64:67], v[24:27]
  ds_write_b32 v7, v20 offset:12
  v_mfma_f32_16x16x32_bf16 v[28:31], a[84:87], v[64:67], v[28:31]
  ds_write_b32 v7, v21 offset:28
  v_mfma_f32_16x16x32_bf16 v[32:35], a[88:91], v[64:67], v[32:35]
  ds_write_b32 v7, v22 offset:44
  v_mfma_f32_16x16x32_bf16 v[36:39], a[92:95], v[64:67], v[36:39]
  ds_write_b32 v7, v23 offset:60
  buffer_load_dwordx4 v[64:67], v1, s[48:51], s82 offen offset:0 sc1
  s_waitcnt vmcnt(9)
  v_mfma_f32_16x16x32_bf16 v[24:27], a[96:99], v[68:71], v[24:27]
  v_mov_b32 v5, 1
  s_mov_b64 exec, 1
  ds_add_u32 v0, v5 offset:108
  s_mov_b64 exec, -1
  v_mfma_f32_16x16x32_bf16 v[28:31], a[100:103], v[68:71], v[28:31]
  v_mfma_f32_16x16x32_bf16 v[32:35], a[104:107], v[68:71], v[32:35]
  v_mfma_f32_16x16x32_bf16 v[36:39], a[108:111], v[68:71], v[36:39]
  buffer_load_dwordx4 v[68:71], v1, s[48:51], s82 offen offset:1024 sc1
  s_waitcnt vmcnt(9)
  v_mfma_f32_16x16x32_bf16 v[24:27], a[112:115], v[72:75], v[24:27]
  v_mfma_f32_16x16x32_bf16 v[28:31], a[116:119], v[72:75], v[28:31]
  v_mfma_f32_16x16x32_bf16 v[32:35], a[120:123], v[72:75], v[32:35]
  v_mfma_f32_16x16x32_bf16 v[36:39], a[124:127], v[72:75], v[36:39]
  buffer_load_dwordx4 v[72:75], v1, s[48:51], s82 offen offset:2048 sc1
  s_waitcnt vmcnt(9)
  v_mfma_f32_16x16x32_bf16 v[24:27], v[80:83], v[76:79], v[24:27]
  v_mfma_f32_16x16x32_bf16 v[28:31], v[84:87], v[76:79], v[28:31]
  v_mfma_f32_16x16x32_bf16 v[32:35], v[88:91], v[76:79], v[32:35]
  v_mfma_f32_16x16x32_bf16 v[36:39], v[92:95], v[76:79], v[36:39]
  buffer_load_dwordx4 v[76:79], v1, s[48:51], s82 offen offset:3072 sc1
  ds_read_b32 v3, v0 offset:104
  s_waitcnt vmcnt(9)
  v_mfma_f32_16x16x32_bf16 v[24:27], v[96:99], v[40:43], v[24:27]
  v_mfma_f32_16x16x32_bf16 v[28:31], v[100:103], v[40:43], v[28:31]
  v_mfma_f32_16x16x32_bf16 v[32:35], v[104:107], v[40:43], v[32:35]
  v_mfma_f32_16x16x32_bf16 v[36:39], v[108:111], v[40:43], v[36:39]
  buffer_load_dwordx4 v[40:43], v2, s[48:51], s82 offen offset:0 sc1
  s_waitcnt vmcnt(9)
  s_cmp_eq_u32 s64, 3
  s_cbranch_scc1 L121
  v_mfma_f32_16x16x32_bf16 v[24:27], v[112:115], v[44:47], v[24:27]
  v_mfma_f32_16x16x32_bf16 v[28:31], v[116:119], v[44:47], v[28:31]
  v_mfma_f32_16x16x32_bf16 v[32:35], v[120:123], v[44:47], v[32:35]
  v_mfma_f32_16x16x32_bf16 v[36:39], v[124:127], v[44:47], v[36:39]
L121:
  buffer_load_dwordx4 v[44:47], v2, s[48:51], s82 offen offset:1024 sc1
  s_waitcnt vmcnt(9)
  v_mfma_f32_16x16x32_bf16 v[8:11], a[0:3], v[48:51], 0
  v_mfma_f32_16x16x32_bf16 v[12:15], a[4:7], v[48:51], 0
  v_mfma_f32_16x16x32_bf16 v[16:19], a[8:11], v[48:51], 0
  v_mfma_f32_16x16x32_bf16 v[20:23], a[12:15], v[48:51], 0
  buffer_load_dwordx4 v[48:51], v2, s[48:51], s82 offen offset:2048 sc1
  s_waitcnt lgkmcnt(0)
  v_cmp_gt_u32 vcc, 1, v3
  s_cbranch_vccnz L122
  s_waitcnt vmcnt(9)
  v_mfma_f32_16x16x32_bf16 v[8:11], a[16:19], v[52:55], v[8:11]
  v_mfma_f32_16x16x32_bf16 v[12:15], a[20:23], v[52:55], v[12:15]
  v_mfma_f32_16x16x32_bf16 v[16:19], a[24:27], v[52:55], v[16:19]
  v_mfma_f32_16x16x32_bf16 v[20:23], a[28:31], v[52:55], v[20:23]
  buffer_load_dwordx4 v[52:55], v4, s[48:51], s83 offen offset:0 sc1
  s_waitcnt vmcnt(9)
  v_mfma_f32_16x16x32_bf16 v[8:11], a[32:35], v[56:59], v[8:11]
  ds_write_b32 v7, v24 offset:16896
  v_mfma_f32_16x16x32_bf16 v[12:15], a[36:39], v[56:59], v[12:15]
  ds_write_b32 v7, v25 offset:16912
  v_mfma_f32_16x16x32_bf16 v[16:19], a[40:43], v[56:59], v[16:19]
  ds_write_b32 v7, v26 offset:16928
  v_mfma_f32_16x16x32_bf16 v[20:23], a[44:47], v[56:59], v[20:23]
  ds_write_b32 v7, v27 offset:16944
  buffer_load_dwordx4 v[56:59], v4, s[48:51], s83 offen offset:1024 sc1
  s_waitcnt vmcnt(9)
  v_mfma_f32_16x16x32_bf16 v[8:11], a[48:51], v[60:63], v[8:11]
  ds_write_b32 v7, v28 offset:16900
  v_mfma_f32_16x16x32_bf16 v[12:15], a[52:55], v[60:63], v[12:15]
  ds_write_b32 v7, v29 offset:16916
  v_mfma_f32_16x16x32_bf16 v[16:19], a[56:59], v[60:63], v[16:19]
  ds_write_b32 v7, v30 offset:16932
  v_mfma_f32_16x16x32_bf16 v[20:23], a[60:63], v[60:63], v[20:23]
  ds_write_b32 v7, v31 offset:16948
  buffer_load_dwordx4 v[60:63], v4, s[48:51], s83 offen offset:2048 sc1
  s_waitcnt vmcnt(9)
  v_mfma_f32_16x16x32_bf16 v[8:11], a[64:67], v[64:67], v[8:11]
  ds_write_b32 v7, v32 offset:16904
  v_mfma_f32_16x16x32_bf16 v[12:15], a[68:71], v[64:67], v[12:15]
  ds_write_b32 v7, v33 offset:16920
  v_mfma_f32_16x16x32_bf16 v[16:19], a[72:75], v[64:67], v[16:19]
  ds_write_b32 v7, v34 offset:16936
  v_mfma_f32_16x16x32_bf16 v[20:23], a[76:79], v[64:67], v[20:23]
  ds_write_b32 v7, v35 offset:16952
  buffer_load_dwordx4 v[64:67], v4, s[48:51], s83 offen offset:3072 sc1
  s_waitcnt vmcnt(9)
  v_mfma_f32_16x16x32_bf16 v[8:11], a[80:83], v[68:71], v[8:11]
  ds_write_b32 v7, v36 offset:16908
  v_mfma_f32_16x16x32_bf16 v[12:15], a[84:87], v[68:71], v[12:15]
  ds_write_b32 v7, v37 offset:16924
  v_mfma_f32_16x16x32_bf16 v[16:19], a[88:91], v[68:71], v[16:19]
  ds_write_b32 v7, v38 offset:16940
  v_mfma_f32_16x16x32_bf16 v[20:23], a[92:95], v[68:71], v[20:23]
  ds_write_b32 v7, v39 offset:16956
  buffer_load_dwordx4 v[68:71], v1, s[48:51], s83 offen offset:0 sc1
  s_waitcnt vmcnt(9)
  v_mfma_f32_16x16x32_bf16 v[8:11], a[96:99], v[72:75], v[8:11]
  v_mov_b32 v5, 1
  s_mov_b64 exec, 1
  ds_add_u32 v0, v5 offset:112
  s_mov_b64 exec, -1
  v_mfma_f32_16x16x32_bf16 v[12:15], a[100:103], v[72:75], v[12:15]
  v_mfma_f32_16x16x32_bf16 v[16:19], a[104:107], v[72:75], v[16:19]
  v_mfma_f32_16x16x32_bf16 v[20:23], a[108:111], v[72:75], v[20:23]
  buffer_load_dwordx4 v[72:75], v1, s[48:51], s83 offen offset:1024 sc1
  s_waitcnt vmcnt(9)
  v_mfma_f32_16x16x32_bf16 v[8:11], a[112:115], v[76:79], v[8:11]
  v_mfma_f32_16x16x32_bf16 v[12:15], a[116:119], v[76:79], v[12:15]
  v_mfma_f32_16x16x32_bf16 v[16:19], a[120:123], v[76:79], v[16:19]
  v_mfma_f32_16x16x32_bf16 v[20:23], a[124:127], v[76:79], v[20:23]
  buffer_load_dwordx4 v[76:79], v1, s[48:51], s83 offen offset:2048 sc1
  s_waitcnt vmcnt(9)
  v_mfma_f32_16x16x32_bf16 v[8:11], v[80:83], v[40:43], v[8:11]
  v_mfma_f32_16x16x32_bf16 v[12:15], v[84:87], v[40:43], v[12:15]
  v_mfma_f32_16x16x32_bf16 v[16:19], v[88:91], v[40:43], v[16:19]
  v_mfma_f32_16x16x32_bf16 v[20:23], v[92:95], v[40:43], v[20:23]
  buffer_load_dwordx4 v[40:43], v1, s[48:51], s83 offen offset:3072 sc1
  s_waitcnt vmcnt(9)
  v_mfma_f32_16x16x32_bf16 v[8:11], v[96:99], v[44:47], v[8:11]
  v_mfma_f32_16x16x32_bf16 v[12:15], v[100:103], v[44:47], v[12:15]
  v_mfma_f32_16x16x32_bf16 v[16:19], v[104:107], v[44:47], v[16:19]
  v_mfma_f32_16x16x32_bf16 v[20:23], v[108:111], v[44:47], v[20:23]
  buffer_load_dwordx4 v[44:47], v2, s[48:51], s83 offen offset:0 sc1
  s_waitcnt vmcnt(9)
  s_cmp_eq_u32 s64, 3
  s_cbranch_scc1 L124
  v_mfma_f32_16x16x32_bf16 v[8:11], v[112:115], v[48:51], v[8:11]
  v_mfma_f32_16x16x32_bf16 v[12:15], v[116:119], v[48:51], v[12:15]
  v_mfma_f32_16x16x32_bf16 v[16:19], v[120:123], v[48:51], v[16:19]
  v_mfma_f32_16x16x32_bf16 v[20:23], v[124:127], v[48:51], v[20:23]
L124:
  buffer_load_dwordx4 v[48:51], v2, s[48:51], s83 offen offset:1024 sc1
  s_waitcnt vmcnt(9)
  v_mfma_f32_16x16x32_bf16 v[24:27], a[0:3], v[52:55], 0
  v_mfma_f32_16x16x32_bf16 v[28:31], a[4:7], v[52:55], 0
  v_mfma_f32_16x16x32_bf16 v[32:35], a[8:11], v[52:55], 0
  v_mfma_f32_16x16x32_bf16 v[36:39], a[12:15], v[52:55], 0
  buffer_load_dwordx4 v[52:55], v2, s[48:51], s83 offen offset:2048 sc1
  ds_write_b32 v7, v8 offset:33792
  ds_write_b32 v7, v9 offset:33808
  ds_write_b32 v7, v10 offset:33824
  ds_write_b32 v7, v11 offset:33840
  ds_write_b32 v7, v12 offset:33796
  ds_write_b32 v7, v13 offset:33812
  ds_write_b32 v7, v14 offset:33828
  ds_write_b32 v7, v15 offset:33844
  ds_write_b32 v7, v16 offset:33800
  ds_write_b32 v7, v17 offset:33816
  ds_write_b32 v7, v18 offset:33832
  ds_write_b32 v7, v19 offset:33848
  ds_write_b32 v7, v20 offset:33804
  ds_write_b32 v7, v21 offset:33820
  ds_write_b32 v7, v22 offset:33836
  ds_write_b32 v7, v23 offset:33852
  v_mov_b32 v5, 1
  s_mov_b64 exec, 1
  ds_add_u32 v0, v5 offset:116
  s_mov_b64 exec, -1
  s_nop 1
  s_branch L123
L122:
  s_waitcnt vmcnt(9)
  v_mfma_f32_16x16x32_bf16 v[8:11], a[16:19], v[52:55], v[8:11]
  v_mfma_f32_16x16x32_bf16 v[12:15], a[20:23], v[52:55], v[12:15]
  v_mfma_f32_16x16x32_bf16 v[16:19], a[24:27], v[52:55], v[16:19]
  v_mfma_f32_16x16x32_bf16 v[20:23], a[28:31], v[52:55], v[20:23]
  s_waitcnt vmcnt(8)
  v_mfma_f32_16x16x32_bf16 v[8:11], a[32:35], v[56:59], v[8:11]
  ds_write_b32 v7, v24 offset:16896
  v_mfma_f32_16x16x32_bf16 v[12:15], a[36:39], v[56:59], v[12:15]
  ds_write_b32 v7, v25 offset:16912
  v_mfma_f32_16x16x32_bf16 v[16:19], a[40:43], v[56:59], v[16:19]
  ds_write_b32 v7, v26 offset:16928
  v_mfma_f32_16x16x32_bf16 v[20:23], a[44:47], v[56:59], v[20:23]
  ds_write_b32 v7, v27 offset:16944
  s_waitcnt vmcnt(7)
  v_mfma_f32_16x16x32_bf16 v[8:11], a[48:51], v[60:63], v[8:11]
  ds_write_b32 v7, v28 offset:16900
  v_mfma_f32_16x16x32_bf16 v[12:15], a[52:55], v[60:63], v[12:15]
  ds_write_b32 v7, v29 offset:16916
  v_mfma_f32_16x16x32_bf16 v[16:19], a[56:59], v[60:63], v[16:19]
  ds_write_b32 v7, v30 offset:16932
  v_mfma_f32_16x16x32_bf16 v[20:23], a[60:63], v[60:63], v[20:23]
  ds_write_b32 v7, v31 offset:16948
  s_waitcnt vmcnt(6)
  v_mfma_f32_16x16x32_bf16 v[8:11], a[64:67], v[64:67], v[8:11]
  ds_write_b32 v7, v32 offset:16904
  v_mfma_f32_16x16x32_bf16 v[12:15], a[68:71], v[64:67], v[12:15]
  ds_write_b32 v7, v33 offset:16920
  v_mfma_f32_16x16x32_bf16 v[16:19], a[72:75], v[64:67], v[16:19]
  ds_write_b32 v7, v34 offset:16936
  v_mfma_f32_16x16x32_bf16 v[20:23], a[76:79], v[64:67], v[20:23]
  ds_write_b32 v7, v35 offset:16952
  s_waitcnt vmcnt(5)
  v_mfma_f32_16x16x32_bf16 v[8:11], a[80:83], v[68:71], v[8:11]
  ds_write_b32 v7, v36 offset:16908
  v_mfma_f32_16x16x32_bf16 v[12:15], a[84:87], v[68:71], v[12:15]
  ds_write_b32 v7, v37 offset:16924
  v_mfma_f32_16x16x32_bf16 v[16:19], a[88:91], v[68:71], v[16:19]
  ds_write_b32 v7, v38 offset:16940
  v_mfma_f32_16x16x32_bf16 v[20:23], a[92:95], v[68:71], v[20:23]
  ds_write_b32 v7, v39 offset:16956
  s_waitcnt vmcnt(4)
  v_mfma_f32_16x16x32_bf16 v[8:11], a[96:99], v[72:75], v[8:11]
  v_mov_b32 v5, 1
  s_mov_b64 exec, 1
  ds_add_u32 v0, v5 offset:112
  s_mov_b64 exec, -1
  v_mfma_f32_16x16x32_bf16 v[12:15], a[100:103], v[72:75], v[12:15]
  v_mfma_f32_16x16x32_bf16 v[16:19], a[104:107], v[72:75], v[16:19]
  v_mfma_f32_16x16x32_bf16 v[20:23], a[108:111], v[72:75], v[20:23]
  s_waitcnt vmcnt(3)
  v_mfma_f32_16x16x32_bf16 v[8:11], a[112:115], v[76:79], v[8:11]
  v_mfma_f32_16x16x32_bf16 v[12:15], a[116:119], v[76:79], v[12:15]
  v_mfma_f32_16x16x32_bf16 v[16:19], a[120:123], v[76:79], v[16:19]
  v_mfma_f32_16x16x32_bf16 v[20:23], a[124:127], v[76:79], v[20:23]
  s_waitcnt vmcnt(2)
  v_mfma_f32_16x16x32_bf16 v[8:11], v[80:83], v[40:43], v[8:11]
  v_mfma_f32_16x16x32_bf16 v[12:15], v[84:87], v[40:43], v[12:15]
  v_mfma_f32_16x16x32_bf16 v[16:19], v[88:91], v[40:43], v[16:19]
  v_mfma_f32_16x16x32_bf16 v[20:23], v[92:95], v[40:43], v[20:23]
  s_waitcnt vmcnt(1)
  v_mfma_f32_16x16x32_bf16 v[8:11], v[96:99], v[44:47], v[8:11]
  v_mfma_f32_16x16x32_bf16 v[12:15], v[100:103], v[44:47], v[12:15]
  v_mfma_f32_16x16x32_bf16 v[16:19], v[104:107], v[44:47], v[16:19]
  v_mfma_f32_16x16x32_bf16 v[20:23], v[108:111], v[44:47], v[20:23]
  s_waitcnt vmcnt(0)
  s_cmp_eq_u32 s64, 3
  s_cbranch_scc1 L125
  v_mfma_f32_16x16x32_bf16 v[8:11], v[112:115], v[48:51], v[8:11]
  v_mfma_f32_16x16x32_bf16 v[12:15], v[116:119], v[48:51], v[12:15]
  v_mfma_f32_16x16x32_bf16 v[16:19], v[120:123], v[48:51], v[16:19]
  v_mfma_f32_16x16x32_bf16 v[20:23], v[124:127], v[48:51], v[20:23]
L125:
  s_nop 4
  ds_write_b32 v7, v8 offset:33792
  ds_write_b32 v7, v9 offset:33808
  ds_write_b32 v7, v10 offset:33824
  ds_write_b32 v7, v11 offset:33840
  ds_write_b32 v7, v12 offset:33796
  ds_write_b32 v7, v13 offset:33812
  ds_write_b32 v7, v14 offset:33828
  ds_write_b32 v7, v15 offset:33844
  ds_write_b32 v7, v16 offset:33800
  ds_write_b32 v7, v17 offset:33816
  ds_write_b32 v7, v18 offset:33832
  ds_write_b32 v7, v19 offset:33848
  ds_write_b32 v7, v20 offset:33804
  ds_write_b32 v7, v21 offset:33820
  ds_write_b32 v7, v22 offset:33836
  ds_write_b32 v7, v23 offset:33852
  v_mov_b32 v5, 1
  s_mov_b64 exec, 1
  ds_add_u32 v0, v5 offset:116
  s_mov_b64 exec, -1
  s_mov_b32 s79, 0x400000
L126:
  ds_read_b32 v5, v0 offset:104
  s_waitcnt lgkmcnt(0)
  v_cmp_gt_u32 vcc, 1, v5
  s_cbranch_vccz L127
  s_sleep 1
  s_sub_u32 s79, s79, 1
  s_cbranch_scc0 L126
L127:
  buffer_load_dwordx4 v[52:55], v4, s[48:51], s83 offen offset:0 sc1
  buffer_load_dwordx4 v[56:59], v4, s[48:51], s83 offen offset:1024 sc1
  buffer_load_dwordx4 v[60:63], v4, s[48:51], s83 offen offset:2048 sc1
  buffer_load_dwordx4 v[64:67], v4, s[48:51], s83 offen offset:3072 sc1
  buffer_load_dwordx4 v[68:71], v1, s[48:51], s83 offen offset:0 sc1
  buffer_load_dwordx4 v[72:75], v1, s[48:51], s83 offen offset:1024 sc1
  buffer_load_dwordx4 v[76:79], v1, s[48:51], s83 offen offset:2048 sc1
  buffer_load_dwordx4 v[40:43], v1, s[48:51], s83 offen offset:3072 sc1
  buffer_load_dwordx4 v[44:47], v2, s[48:51], s83 offen offset:0 sc1
  buffer_load_dwordx4 v[48:51], v2, s[48:51], s83 offen offset:1024 sc1
  s_waitcnt vmcnt(9)
  v_mfma_f32_16x16x32_bf16 v[24:27], a[0:3], v[52:55], 0
  v_mfma_f32_16x16x32_bf16 v[28:31], a[4:7], v[52:55], 0
  v_mfma_f32_16x16x32_bf16 v[32:35], a[8:11], v[52:55], 0
  v_mfma_f32_16x16x32_bf16 v[36:39], a[12:15], v[52:55], 0
  buffer_load_dwordx4 v[52:55], v2, s[48:51], s83 offen offset:2048 sc1
  s_nop 6
L123:
  s_waitcnt vmcnt(9)
  v_mfma_f32_16x16x32_bf16 v[24:27], a[16:19], v[56:59], v[24:27]
  v_mfma_f32_16x16x32_bf16 v[28:31], a[20:23], v[56:59], v[28:31]
  v_mfma_f32_16x16x32_bf16 v[32:35], a[24:27], v[56:59], v[32:35]
  v_mfma_f32_16x16x32_bf16 v[36:39], a[28:31], v[56:59], v[36:39]
  s_waitcnt vmcnt(8)
  v_mfma_f32_16x16x32_bf16 v[24:27], a[32:35], v[60:63], v[24:27]
  v_mfma_f32_16x16x32_bf16 v[28:31], a[36:39], v[60:63], v[28:31]
  v_mfma_f32_16x16x32_bf16 v[32:35], a[40:43], v[60:63], v[32:35]
  v_mfma_f32_16x16x32_bf16 v[36:39], a[44:47], v[60:63], v[36:39]
  s_waitcnt vmcnt(7)
  v_mfma_f32_16x16x32_bf16 v[24:27], a[48:51], v[64:67], v[24:27]
  v_mfma_f32_16x16x32_bf16 v[28:31], a[52:55], v[64:67], v[28:31]
  v_mfma_f32_16x16x32_bf16 v[32:35], a[56:59], v[64:67], v[32:35]
  v_mfma_f32_16x16x32_bf16 v[36:39], a[60:63], v[64:67], v[36:39]
  s_waitcnt vmcnt(6)
  v_mfma_f32_16x16x32_bf16 v[24:27], a[64:67], v[68:71], v[24:27]
  v_mfma_f32_16x16x32_bf16 v[28:31], a[68:71], v[68:71], v[28:31]
  v_mfma_f32_16x16x32_bf16 v[32:35], a[72:75], v[68:71], v[32:35]
  v_mfma_f32_16x16x32_bf16 v[36:39], a[76:79], v[68:71], v[36:39]
  s_waitcnt vmcnt(5)
  v_mfma_f32_16x16x32_bf16 v[24:27], a[80:83], v[72:75], v[24:27]
  v_mfma_f32_16x16x32_bf16 v[28:31], a[84:87], v[72:75], v[28:31]
  v_mfma_f32_16x16x32_bf16 v[32:35], a[88:91], v[72:75], v[32:35]
  v_mfma_f32_16x16x32_bf16 v[36:39], a[92:95], v[72:75], v[36:39]
  s_waitcnt vmcnt(4)
  v_mfma_f32_16x16x32_bf16 v[24:27], a[96:99], v[76:79], v[24:27]
  v_mfma_f32_16x16x32_bf16 v[28:31], a[100:103], v[76:79], v[28:31]
  v_mfma_f32_16x16x32_bf16 v[32:35], a[104:107], v[76:79], v[32:35]
  v_mfma_f32_16x16x32_bf16 v[36:39], a[108:111], v[76:79], v[36:39]
  s_waitcnt vmcnt(3)
  v_mfma_f32_16x16x32_bf16 v[24:27], a[112:115], v[40:43], v[24:27]
  v_mfma_f32_16x16x32_bf16 v[28:31], a[116:119], v[40:43], v[28:31]
  v_mfma_f32_16x16x32_bf16 v[32:35], a[120:123], v[40:43], v[32:35]
  v_mfma_f32_16x16x32_bf16 v[36:39], a[124:127], v[40:43], v[36:39]
  s_waitcnt vmcnt(2)
  v_mfma_f32_16x16x32_bf16 v[24:27], v[80:83], v[44:47], v[24:27]
  v_mfma_f32_16x16x32_bf16 v[28:31], v[84:87], v[44:47], v[28:31]
  v_mfma_f32_16x16x32_bf16 v[32:35], v[88:91], v[44:47], v[32:35]
  v_mfma_f32_16x16x32_bf16 v[36:39], v[92:95], v[44:47], v[36:39]
  s_waitcnt vmcnt(1)
  v_mfma_f32_16x16x32_bf16 v[24:27], v[96:99], v[48:51], v[24:27]
  v_mfma_f32_16x16x32_bf16 v[28:31], v[100:103], v[48:51], v[28:31]
  v_mfma_f32_16x16x32_bf16 v[32:35], v[104:107], v[48:51], v[32:35]
  v_mfma_f32_16x16x32_bf16 v[36:39], v[108:111], v[48:51], v[36:39]
  s_waitcnt vmcnt(0)
  s_cmp_eq_u32 s64, 3
  s_cbranch_scc1 L128
  v_mfma_f32_16x16x32_bf16 v[24:27], v[112:115], v[52:55], v[24:27]
  v_mfma_f32_16x16x32_bf16 v[28:31], v[116:119], v[52:55], v[28:31]
  v_mfma_f32_16x16x32_bf16 v[32:35], v[120:123], v[52:55], v[32:35]
  v_mfma_f32_16x16x32_bf16 v[36:39], v[124:127], v[52:55], v[36:39]
L128:
  s_nop 4
  ds_write_b32 v7, v24 offset:50688
  ds_write_b32 v7, v25 offset:50704
  ds_write_b32 v7, v26 offset:50720
  ds_write_b32 v7, v27 offset:50736
  ds_write_b32 v7, v28 offset:50692
  ds_write_b32 v7, v29 offset:50708
  ds_write_b32 v7, v30 offset:50724
  ds_write_b32 v7, v31 offset:50740
  ds_write_b32 v7, v32 offset:50696
  ds_write_b32 v7, v33 offset:50712
  ds_write_b32 v7, v34 offset:50728
  ds_write_b32 v7, v35 offset:50744
  ds_write_b32 v7, v36 offset:50700
  ds_write_b32 v7, v37 offset:50716
  ds_write_b32 v7, v38 offset:50732
  ds_write_b32 v7, v39 offset:50748
  v_mov_b32 v5, 1
  s_mov_b64 exec, 1
  ds_add_u32 v0, v5 offset:120
  s_mov_b64 exec, -1
Lend:
  s_endpgm
.section .rodata,"a"
.p2align 6
.amdhsa_kernel sequential_preLN__spectral_fnet__swiglu_ffn__prompt_kernel
  .amdhsa_next_free_vgpr 256
  .amdhsa_next_free_sgpr 102
  .amdhsa_accum_offset 128
  .amdhsa_group_segment_fixed_size 0
  .amdhsa_kernarg_size 96
  .amdhsa_user_sgpr_count 2
  .amdhsa_user_sgpr_kernarg_segment_ptr 1
  .amdhsa_system_sgpr_workgroup_id_x 1
.end_amdhsa_kernel
```
